```python
import torch

def _softmax(x, axis=-1):
    return torch.softmax(x, dim=axis)

def _gelu(x):
    return torch.nn.functional.gelu(x, approximate='tanh')

def _silu(x):
    return torch.nn.functional.silu(x)

def _sigmoid(x):
    return torch.sigmoid(x)

def _layernorm(x, axis=-1, eps=1e-05):
    m = x.mean(dim=axis, keepdim=True)
    v = x.var(dim=axis, keepdim=True, unbiased=False)
    return (x - m) / torch.sqrt(v + eps)

def _scatter_add(tgt, idx, src, axis=0):
    return tgt.clone().index_add_(axis, idx, src)

def _segment_sum(src, seg, n):
    out = torch.zeros((n,) + src.shape[1:], dtype=src.dtype)
    return out.index_add_(0, seg, src)

def _pad(x, pw):
    flat = tuple((v for pair in reversed(pw) for v in pair))
    return torch.nn.functional.pad(x, flat)
kernel_name = 'standalone__autoregressive_conv_wavenet__speech'

def setup_inputs():

    _w = lambda a: (lambda t: t.to(torch.bfloat16) if t.is_floating_point() else t)(torch.as_tensor(a))
    B, T, D, K = (2, 4000, 144, 15)
    return {'x': _w((lambda *s: torch.randn(*s, dtype=torch.bfloat16) * 0.1)(B, T, D)), 'w': _w((lambda *s: torch.randn(*s, dtype=torch.bfloat16) * 0.1)(K, D, 2 * D)), 'w_o': _w((lambda *s: torch.randn(*s, dtype=torch.bfloat16) * 0.05)(D, D))}

def reference(x, w, w_o):
    B, T, D = x.shape
    K = w.shape[0]
    dil = 2
    pad = (K - 1) * dil
    xp = _pad(x, ((0, 0), (pad, 0), (0, 0)))
    h = torch.einsum('btc,cd->btd', xp[:, pad:pad + T, :], w[0])
    for i in range(1, K):
        off = pad - i * dil
        h = h + torch.einsum('btc,cd->btd', xp[:, off:off + T, :], w[i])
    f = h[..., :D].clone()
    g = h[..., D:].clone()
    z = torch.tanh(f) * _sigmoid(g)
    return z @ w_o
```

```asm
; @launch grid=(256,1,1) block=(512,1,1) lds=163840
.amdgcn_target "amdgcn-amd-amdhsa--gfx950"
.text
.globl standalone__autoregressive_conv_wavenet__speech_kernel
.p2align 12
.p2align 8
.type standalone__autoregressive_conv_wavenet__speech_kernel,@function
standalone__autoregressive_conv_wavenet__speech_kernel:
s_load_dwordx4 s[4:7], s[0:1], 0
s_load_dwordx4 s[8:11], s[0:1], 16
s_load_dwordx4 s[12:15], s[0:1], 32
v_lshrrev_b32 v1, 6, v0
s_xor_b32 s50, s2, 0
s_and_b32 s50, s50, 0xf9
s_cmp_eq_u32 s50, 0xf9
s_cbranch_scc1 L_end
s_cmp_ge_u32 s2, 256
s_cbranch_scc1 L_end
v_readfirstlane_b32 s44, v1
v_and_b32 v0, 63, v0
s_and_b32 s50, s2, 7
s_lshr_b32 s51, s2, 3
s_lshl_b32 s52, s50, 5
s_add_u32 s51, s51, s52
s_lshr_b32 s52, s50, 1
s_sub_u32 s45, s51, s52
s_mul_i32 s46, s45, 7282
s_lshr_b32 s46, s46, 16
s_mul_i32 s50, s46, 9
s_sub_u32 s47, s45, s50
s_cmp_lt_u32 s44, 4
s_cbranch_scc1 L_C
s_cmp_ge_u32 s46, 14
s_cselect_b32 s48, 1152000, 0
s_cselect_b32 s50, 14, 0
s_sub_u32 s50, s46, s50
s_mul_i32 s49, s50, 288
s_sub_u32 s53, s44, 4
v_lshlrev_b32 v14, 4, v0
s_mul_i32 s50, s49, 288
s_sub_u32 s50, s50, 8640
v_add_u32 v12, s50, v14
s_cmp_lt_u32 s53, 2
s_cselect_b32 s58, 23, 22
s_mul_i32 s59, s58, 4096
s_lshl_b32 s50, s47, 1
s_sub_u32 s51, s50, 9
s_min_u32 s50, s50, s51
s_mul_i32 s50, s50, 5
s_lshr_b32 s50, s50, 1
s_mul_i32 s50, s50, 4096
s_lshl_b32 s51, s53, 10
s_add_u32 s54, s50, s51
s_setprio 1
v_lshrrev_b32 v5, 2, v0
v_mul_u32_u24 v5, 576, v5
v_lshrrev_b32 v6, 5, v0
v_lshlrev_b32 v6, 1, v6
v_and_b32 v7, 3, v0
v_xor_b32 v6, v6, v7
v_lshl_add_u32 v5, v6, 4, v5
s_lshl_b32 s50, s47, 6
v_add_u32 v10, s50, v5
s_mul_i32 s64, s53, 82944
s_add_u32 s64, s64, 73728
s_lshl_b32 s51, s53, 10
s_add_u32 s55, s51, 92160
s_mov_b32 m0, s55
s_mov_b32 s22, 1244160
s_mov_b32 s23, 0x20000
s_waitcnt lgkmcnt(0)
s_mov_b32 s20, s6
s_and_b32 s21, s7, 0xffff
buffer_load_dwordx4 v10, s[20:23], s64 offen lds
s_add_u32 s4, s4, s48
s_addc_u32 s5, s5, 0
s_mov_b32 s16, s4
s_and_b32 s17, s5, 0xffff
s_mov_b32 s18, 1152000
s_mov_b32 s19, 0x20000
s_mov_b32 m0, s54
s_mov_b32 s56, 0
L_xloop0:
v_add_u32 v13, m0, v12
s_add_u32 s56, s56, 1
buffer_load_dwordx4 v13, s[16:19], 0 offen lds
s_add_u32 s51, m0, 4096
s_cmp_ge_u32 s51, s59
s_cselect_b32 s52, s59, 0
s_sub_u32 m0, s51, s52
s_cmp_lg_u32 s53, 3
s_cbranch_scc1 L_xloop
s_mul_i32 s51, s46, 73728
s_lshl_b32 s52, s45, 10
s_add_u32 s51, s51, s52
s_add_u32 s51, s51, 405504
s_sub_u32 s50, s45, 99
s_mul_i32 s52, s50, 3641
s_lshr_b32 s52, s52, 16
s_mul_i32 s52, s52, 64512
s_lshl_b32 s50, s50, 10
s_add_u32 s52, s52, s50
s_cmp_lt_u32 s45, 99
s_cselect_b32 s51, s51, s52
v_add_u32 v19, s51, v14
buffer_load_dwordx4 v[24:27], v19, s[20:23], 0 offen
L_xloop:
v_add_u32 v13, m0, v12
s_add_u32 s56, s56, 1
buffer_load_dwordx4 v13, s[16:19], 0 offen lds
s_add_u32 s51, m0, 4096
s_cmp_ge_u32 s51, s59
s_cselect_b32 s52, s59, 0
s_sub_u32 m0, s51, s52
s_cmp_lt_u32 s56, s58
s_cbranch_scc1 L_xloop
v_lshl_add_u32 v1, v0, 2, s53
v_mul_u32_u24 v4, 82944, v1
v_lshrrev_b32 v2, 1, v1
v_subrev_u32 v2, 8, v2
v_mul_u32_u24 v3, 4370, v2
v_lshrrev_b32 v3, 16, v3
v_mul_u32_u24 v5, 15, v3
v_sub_u32 v2, v2, v5
v_mul_u32_u24 v2, 82944, v2
v_mul_u32_u24 v3, 18432, v3
s_and_b32 s50, s53, 1
s_mul_i32 s50, s50, 9216
v_cmp_gt_u32 vcc, 16, v1
v_add3_u32 v2, v2, v3, s50
v_add_u32 v4, 73728, v4
v_cndmask_b32 v16, v2, v4, vcc
s_nop 0
v_readlane_b32 s65, v16, 1
v_readlane_b32 s64, v16, 2
s_cmp_eq_u32 s53, 3
s_cselect_b32 s50, 0x80000000, 0
v_or_b32 v11, s50, v10
s_add_u32 m0, s55, 4096
s_nop 0
buffer_load_dwordx4 v10, s[20:23], s65 offen lds
v_readlane_b32 s65, v16, 3
s_add_u32 m0, s55, 8192
s_nop 0
buffer_load_dwordx4 v10, s[20:23], s64 offen lds
v_readlane_b32 s64, v16, 4
s_add_u32 m0, s55, 12288
s_nop 0
buffer_load_dwordx4 v11, s[20:23], s65 offen lds
v_readlane_b32 s65, v16, 5
s_add_u32 m0, s55, 16384
s_nop 0
buffer_load_dwordx4 v10, s[20:23], s64 offen lds
v_readlane_b32 s64, v16, 6
s_add_u32 m0, s55, 20480
s_nop 0
buffer_load_dwordx4 v10, s[20:23], s65 offen lds
v_readlane_b32 s65, v16, 7
s_add_u32 m0, s55, 24576
s_nop 0
buffer_load_dwordx4 v10, s[20:23], s64 offen lds
v_readlane_b32 s64, v16, 8
s_add_u32 m0, s55, 28672
s_nop 0
buffer_load_dwordx4 v10, s[20:23], s65 offen lds
v_readlane_b32 s65, v16, 9
s_waitcnt vmcnt(7)
s_barrier
s_setprio 0
s_waitcnt vmcnt(6)
s_barrier
s_add_u32 m0, s55, 32768
s_nop 0
buffer_load_dwordx4 v10, s[20:23], s64 offen lds
v_readlane_b32 s64, v16, 10
s_add_u32 m0, s55, 36864
s_nop 0
buffer_load_dwordx4 v10, s[20:23], s65 offen lds
v_readlane_b32 s65, v16, 11
s_waitcnt vmcnt(7)
s_barrier
s_add_u32 m0, s55, 40960
s_nop 0
buffer_load_dwordx4 v10, s[20:23], s64 offen lds
v_readlane_b32 s64, v16, 12
s_waitcnt vmcnt(7)
s_barrier
s_add_u32 m0, s55, 45056
s_nop 0
buffer_load_dwordx4 v10, s[20:23], s65 offen lds
v_readlane_b32 s65, v16, 13
s_add_u32 m0, s55, 49152
s_nop 0
buffer_load_dwordx4 v10, s[20:23], s64 offen lds
v_readlane_b32 s64, v16, 14
s_waitcnt vmcnt(8)
s_barrier
s_add_u32 m0, s55, 53248
s_nop 0
buffer_load_dwordx4 v10, s[20:23], s65 offen lds
v_readlane_b32 s65, v16, 15
s_waitcnt vmcnt(7)
s_barrier
s_add_u32 m0, s55, 57344
s_nop 0
buffer_load_dwordx4 v10, s[20:23], s64 offen lds
v_readlane_b32 s64, v16, 16
s_add_u32 m0, s55, 61440
s_nop 0
buffer_load_dwordx4 v10, s[20:23], s65 offen lds
v_readlane_b32 s65, v16, 17
s_add_u32 m0, s55, 0
s_nop 0
buffer_load_dwordx4 v10, s[20:23], s64 offen lds
v_readlane_b32 s64, v16, 18
s_waitcnt vmcnt(8)
s_barrier
s_add_u32 m0, s55, 4096
s_nop 0
buffer_load_dwordx4 v10, s[20:23], s65 offen lds
v_readlane_b32 s65, v16, 19
s_add_u32 m0, s55, 8192
s_nop 0
buffer_load_dwordx4 v10, s[20:23], s64 offen lds
v_readlane_b32 s64, v16, 20
s_add_u32 m0, s55, 12288
s_nop 0
buffer_load_dwordx4 v10, s[20:23], s65 offen lds
v_readlane_b32 s65, v16, 21
s_mul_i32 s51, s46, 165888
s_add_u32 s60, s14, s51
s_addc_u32 s61, s15, 0
s_mov_b32 s32, s60
s_and_b32 s33, s61, 0xffff
s_mov_b32 s34, 165888
s_mov_b32 s35, 0x20000
s_mov_b32 s36, s12
s_and_b32 s37, s13, 0xffff
s_mov_b32 s38, 256
s_mov_b32 s39, 0x20000
s_mov_b32 s24, s8
s_and_b32 s25, s9, 0xffff
s_mov_b32 s26, 41472
s_mov_b32 s27, 0x20000
s_add_u32 s10, s10, s48
s_addc_u32 s11, s11, 0
s_mov_b32 s28, s10
s_and_b32 s29, s11, 0xffff
s_mov_b32 s30, 1152000
s_mov_b32 s31, 0x20000
v_lshlrev_b32 v15, 3, v0
s_mov_b32 s60, 0x61807254
s_mov_b32 s61, 3
s_lshl_b32 s51, s47, 2
s_lshr_b64 s[60:61], s[60:61], s51
s_and_b32 s72, s60, 15
s_mul_i32 s57, s72, 18432
s_mul_i32 s51, s53, 4608
s_add_u32 s58, s57, s51
s_add_u32 s59, s58, 4096
v_mov_b32 v20, -1
v_mov_b32 v21, -1
v_mov_b32 v22, -1
v_mov_b32 v23, -1
s_waitcnt vmcnt(8)
s_barrier
s_add_u32 m0, s55, 16384
s_nop 0
buffer_load_dwordx4 v10, s[20:23], s64 offen lds
v_readlane_b32 s64, v16, 22
s_add_u32 m0, s55, 20480
s_nop 0
buffer_load_dwordx4 v10, s[20:23], s65 offen lds
v_readlane_b32 s65, v16, 23
buffer_store_dwordx4 v[20:23], v14, s[32:35], s58 offen offset:0 sc1
buffer_store_dwordx4 v[20:23], v14, s[32:35], s58 offen offset:1024 sc1
buffer_store_dwordx4 v[20:23], v14, s[32:35], s58 offen offset:2048 sc1
buffer_store_dwordx4 v[20:23], v14, s[32:35], s58 offen offset:3072 sc1
buffer_store_dwordx2 v[20:21], v15, s[32:35], s59 offen sc1
s_waitcnt vmcnt(10)
s_barrier
s_add_u32 m0, s55, 24576
s_nop 0
buffer_load_dwordx4 v10, s[20:23], s64 offen lds
v_readlane_b32 s64, v16, 24
s_add_u32 m0, s55, 28672
s_nop 0
buffer_load_dwordx4 v10, s[20:23], s65 offen lds
v_readlane_b32 s65, v16, 25
s_add_u32 m0, s55, 32768
s_nop 0
buffer_load_dwordx4 v10, s[20:23], s64 offen lds
v_readlane_b32 s64, v16, 26
s_add_u32 m0, s55, 36864
s_nop 0
buffer_load_dwordx4 v10, s[20:23], s65 offen lds
v_readlane_b32 s65, v16, 27
s_add_u32 m0, s55, 40960
s_nop 0
buffer_load_dwordx4 v10, s[20:23], s64 offen lds
v_readlane_b32 s64, v16, 28
s_lshl_b32 s51, s45, 2
s_add_u32 s51, s51, s53
s_mul_i32 s52, s51, 1599
s_lshr_b32 s52, s52, 16
s_mul_i32 s52, s52, 41
s_sub_u32 s51, s51, s52
s_lshl_b32 s51, s51, 10
v_add_u32 v13, s51, v14
buffer_load_dwordx4 v[24:27], v13, s[24:27], 0 offen
s_waitcnt vmcnt(6)
s_barrier
s_cmp_lg_u32 s53, 0
s_cbranch_scc1 L_noatom
s_lshl_b32 s51, s46, 3
v_mov_b32 v1, s51
v_mov_b32 v2, 1
s_mov_b64 exec, 1
buffer_atomic_add v2, v1, s[36:39], 0 offen sc1
s_mov_b64 exec, -1
L_noatom:
s_add_u32 m0, s55, 45056
s_nop 0
buffer_load_dwordx4 v10, s[20:23], s65 offen lds
v_readlane_b32 s65, v16, 29
s_add_u32 m0, s55, 49152
s_nop 0
buffer_load_dwordx4 v10, s[20:23], s64 offen lds
v_readlane_b32 s64, v16, 30
s_add_u32 m0, s55, 53248
s_nop 0
buffer_load_dwordx4 v10, s[20:23], s65 offen lds
v_readlane_b32 s65, v16, 31
s_add_u32 m0, s55, 57344
s_nop 0
buffer_load_dwordx4 v10, s[20:23], s64 offen lds
v_readlane_b32 s64, v16, 32
s_add_u32 m0, s55, 61440
s_nop 0
buffer_load_dwordx4 v10, s[20:23], s65 offen lds
v_readlane_b32 s65, v16, 33
s_waitcnt vmcnt(6)
s_barrier
s_add_u32 m0, s55, 0
s_nop 0
buffer_load_dwordx4 v10, s[20:23], s64 offen lds
s_add_u32 m0, s55, 4096
s_nop 0
buffer_load_dwordx4 v10, s[20:23], s65 offen lds
s_cmp_eq_u32 s53, 0
s_cbranch_scc1 L_ct4
s_cmp_eq_u32 s53, 1
s_cbranch_scc1 L_ct5
s_cmp_eq_u32 s53, 2
s_cbranch_scc1 L_ct6
s_branch L_ct7
L_cr4:
L_cr5:
L_cr6:
L_cr7:
s_waitcnt vmcnt(0)
s_barrier
v_lshrrev_b32 v24, 4, v0
v_and_b32 v25, 15, v0
v_lshrrev_b32 v1, 2, v25
v_lshl_add_u32 v1, v24, 2, v1
v_mul_u32_u24 v1, 288, v1
v_add_u32 v1, 92160, v1
v_and_b32 v26, 3, v0
v_lshl_add_u32 v7, v26, 3, v1
v_lshl_add_u32 v1, v26, 4, v1
s_lshl_b32 s51, s53, 6
v_add_u32 v6, s51, v1
s_add_u32 s51, s53, 0
s_and_b32 s51, s51, 3
s_mul_i32 s52, s51, 9216
v_add_u32 v2, s52, v6
s_lshl_b32 s51, s51, 10
s_add_u32 s51, s51, 135168
v_add_u32 v8, s51, v14
s_add_u32 s51, s53, 1
s_and_b32 s51, s51, 3
s_mul_i32 s52, s51, 9216
v_add_u32 v3, s52, v6
s_lshl_b32 s51, s51, 10
s_add_u32 s51, s51, 135168
v_add_u32 v9, s51, v14
s_add_u32 s51, s53, 2
s_and_b32 s51, s51, 3
s_mul_i32 s52, s51, 9216
v_add_u32 v4, s52, v6
s_lshl_b32 s51, s51, 10
s_add_u32 s51, s51, 135168
v_add_u32 v10, s51, v14
s_add_u32 s51, s53, 3
s_and_b32 s51, s51, 3
s_mul_i32 s52, s51, 9216
v_add_u32 v5, s52, v6
s_lshl_b32 s51, s51, 10
s_add_u32 s51, s51, 135168
v_add_u32 v11, s51, v14
v_add_u32 v12, 139264, v15
s_sub_u32 s51, 9, s72
s_cmp_eq_u32 s72, 0
s_cselect_b32 s51, 0, s51
s_add_u32 s51, s51, 144
s_and_b32 s58, s72, 1
s_cmp_eq_u32 s58, 0
s_cselect_b32 s52, s72, s51
s_cselect_b32 s51, s51, s72
s_cmp_eq_u32 s53, 0
s_cselect_b32 s60, 0, 0x80000000
s_lshl_b32 s59, s53, 6
v_mul_u32_u24 v25, 9, v25
s_add_u32 s52, s52, s49
v_add_u32 v1, s52, v25
v_mul_u32_u24 v1, 288, v1
v_lshl_add_u32 v26, v24, 4, v1
v_add_u32 v20, s59, v26
v_lshl_add_u32 v26, v24, 3, v1
v_or_b32 v22, s60, v26
s_add_u32 s51, s51, s49
v_add_u32 v1, s51, v25
v_mul_u32_u24 v1, 288, v1
v_lshl_add_u32 v26, v24, 4, v1
v_add_u32 v21, s59, v26
v_lshl_add_u32 v26, v24, 3, v1
v_or_b32 v23, s60, v26
s_lshl_b32 s51, s53, 11
s_add_u32 s51, s51, s57
s_lshl_b32 s52, s58, 9
s_add_u32 s64, s51, s52
s_xor_b32 s52, s52, 512
s_add_u32 s65, s51, s52
v_and_b32 v1, 31, v0
v_lshrrev_b32 v26, 5, v0
v_mul_u32_u24 v26, 9216, v26
v_lshl_add_u32 v17, v1, 4, v26
s_cmp_eq_u32 s53, 3
s_cselect_b32 s51, 0, 0x80000000
v_or_b32 v18, s51, v17
s_mov_b32 s61, 0xffff
s_mov_b32 s62, 0xffff0000
s_lshl_b32 s51, s53, 10
v_add_u32 v13, s51, v14
s_add_u32 m0, s51, 92160
v_add_u32 v19, 40960, v14
s_mov_b32 s70, 0
s_cmp_lg_u32 s53, 0
s_cbranch_scc1 L_nopoll
s_mov_b32 s56, 0
s_lshl_b32 s51, s46, 3
v_mov_b32 v1, s51
L_rdy:
buffer_load_dword v24, v1, s[36:39], 0 offen sc1
s_add_u32 s56, s56, 1
s_waitcnt vmcnt(0)
v_readfirstlane_b32 s51, v24
s_cmp_gt_u32 s56, 200000
s_cbranch_scc1 L_nopoll
s_cmp_lt_u32 s51, 9
s_cbranch_scc1 L_rdy
L_nopoll:
s_barrier
buffer_load_dwordx4 v13, s[24:27], s70 offen lds
s_add_u32 m0, m0, 4096
s_add_u32 s70, s70, 4096
buffer_load_dwordx4 v13, s[24:27], s70 offen lds
s_add_u32 m0, m0, 4096
s_add_u32 s70, s70, 4096
buffer_load_dwordx4 v13, s[24:27], s70 offen lds
s_add_u32 m0, m0, 4096
s_add_u32 s70, s70, 4096
buffer_load_dwordx4 v13, s[24:27], s70 offen lds
s_add_u32 m0, m0, 4096
s_add_u32 s70, s70, 4096
buffer_load_dwordx4 v13, s[24:27], s70 offen lds
s_add_u32 m0, m0, 4096
s_add_u32 s70, s70, 4096
buffer_load_dwordx4 v13, s[24:27], s70 offen lds
s_add_u32 m0, m0, 4096
s_add_u32 s70, s70, 4096
buffer_load_dwordx4 v13, s[24:27], s70 offen lds
s_add_u32 m0, m0, 4096
s_add_u32 s70, s70, 4096
buffer_load_dwordx4 v13, s[24:27], s70 offen lds
s_add_u32 m0, m0, 4096
s_add_u32 s70, s70, 4096
buffer_load_dwordx4 v13, s[24:27], s70 offen lds
s_add_u32 m0, m0, 4096
s_add_u32 s70, s70, 4096
buffer_load_dwordx4 v13, s[24:27], s70 offen lds
s_add_u32 m0, m0, 4096
s_add_u32 s70, s70, 4096
s_cmp_lg_u32 s53, 0
s_cbranch_scc1 L_wodone
buffer_load_dwordx4 v19, s[24:27], 0 offen lds
L_wodone:
s_mov_b32 s56, 0
s_waitcnt vmcnt(0)
s_branch L_Hf
.p2align 12
L_ct4:
s_branch L_cr4
L_Hf:
s_barrier
buffer_load_dwordx4 v[24:27], v17, s[32:35], s64 offen offset:0 sc1
buffer_load_dwordx4 v[28:31], v17, s[32:35], s64 offen offset:1024 sc1
buffer_load_dwordx4 v[32:35], v18, s[32:35], s64 offen offset:2048 sc1
ds_read_b64_tr_b16 v[100:101], v2 offset:0
ds_read_b64_tr_b16 v[102:103], v2 offset:4608
ds_read_b64_tr_b16 v[104:105], v3 offset:0
ds_read_b64_tr_b16 v[106:107], v3 offset:4608
ds_read_b64_tr_b16 v[108:109], v4 offset:0
ds_read_b64_tr_b16 v[110:111], v4 offset:4608
ds_read_b64_tr_b16 v[112:113], v5 offset:0
ds_read_b64_tr_b16 v[114:115], v5 offset:4608
ds_read_b64_tr_b16 v[116:117], v6 offset:36864
s_waitcnt lgkmcnt(6)
ds_read_b64_tr_b16 v[118:119], v2 offset:8
ds_read_b64_tr_b16 v[120:121], v2 offset:4616
ds_read_b64_tr_b16 v[122:123], v3 offset:8
ds_read_b64_tr_b16 v[124:125], v3 offset:4616
ds_read_b64_tr_b16 v[126:127], v4 offset:8
ds_read_b64_tr_b16 v[128:129], v4 offset:4616
ds_read_b64_tr_b16 v[130:131], v5 offset:8
ds_read_b64_tr_b16 v[132:133], v5 offset:4616
ds_read_b64_tr_b16 v[134:135], v6 offset:36872
s_waitcnt lgkmcnt(6)
ds_read_b64_tr_b16 v[136:137], v7 offset:256
ds_read_b64_tr_b16 v[138:139], v7 offset:4864
ds_read_b64_tr_b16 v[140:141], v7 offset:9472
ds_read_b64_tr_b16 v[142:143], v7 offset:14080
ds_read_b64_tr_b16 v[144:145], v7 offset:18688
ds_read_b64_tr_b16 v[146:147], v7 offset:23296
ds_read_b64_tr_b16 v[148:149], v7 offset:27904
ds_read_b64_tr_b16 v[150:151], v7 offset:32512
ds_read_b64_tr_b16 v[152:153], v7 offset:37120
s_barrier
buffer_load_dwordx4 v[36:39], v17, s[32:35], s65 offen offset:0 sc1
buffer_load_dwordx4 v[40:43], v17, s[32:35], s65 offen offset:1024 sc1
buffer_load_dwordx4 v[44:47], v18, s[32:35], s65 offen offset:2048 sc1
s_branch L_chk0
s_branch L_Ts5
L_ct5:
s_branch L_cr5
L_Ts5:
L_poll0:
buffer_load_dwordx4 v[24:27], v17, s[32:35], s64 offen offset:0 sc1
buffer_load_dwordx4 v[28:31], v17, s[32:35], s64 offen offset:1024 sc1
buffer_load_dwordx4 v[32:35], v18, s[32:35], s64 offen offset:2048 sc1
s_add_u32 s56, s56, 1
s_waitcnt vmcnt(0)
v_max_u32 v76, v24, v25
v_max3_u32 v76, v76, v26, v27
v_max3_u32 v76, v76, v28, v29
v_max3_u32 v76, v76, v30, v31
v_max3_u32 v76, v76, v32, v33
v_max3_u32 v76, v76, v34, v35
v_cmp_eq_u32 vcc, -1, v76
s_cmp_gt_u32 s56, 200000
s_cbranch_scc1 L_chk0
s_cbranch_vccnz L_poll0
L_chk0:
s_waitcnt vmcnt(5)
v_max3_u32 v76, v24, v25, v26
v_max_u32 v76, v76, v27
v_permlane32_swap_b32 v24, v26
v_permlane32_swap_b32 v25, v27
v_and_b32 v68, s61, v26
v_and_b32 v69, s62, v26
v_and_b32 v72, s61, v27
v_and_b32 v73, s62, v27
v_dot2_f32_bf16 v68, v24, v68, 0
v_dot2_f32_bf16 v69, v24, v69, 0
v_dot2_f32_bf16 v72, v25, v72, 0
v_dot2_f32_bf16 v73, v25, v73, 0
s_nop 1
v_cvt_pk_bf16_f32 v48, v68, v69
v_cvt_pk_bf16_f32 v49, v72, v73
s_waitcnt vmcnt(4)
v_max3_u32 v76, v76, v28, v29
v_max3_u32 v76, v76, v30, v31
v_permlane32_swap_b32 v28, v30
v_permlane32_swap_b32 v29, v31
v_and_b32 v68, s61, v30
v_and_b32 v69, s62, v30
v_and_b32 v72, s61, v31
v_and_b32 v73, s62, v31
v_dot2_f32_bf16 v68, v28, v68, 0
v_dot2_f32_bf16 v69, v28, v69, 0
v_dot2_f32_bf16 v72, v29, v72, 0
v_dot2_f32_bf16 v73, v29, v73, 0
s_nop 1
v_cvt_pk_bf16_f32 v50, v68, v69
v_cvt_pk_bf16_f32 v51, v72, v73
ds_write_b128 v8, v[48:51] offset:0
s_cmp_lg_u32 s53, 3
s_cbranch_scc1 L_no80
s_waitcnt vmcnt(3)
v_max3_u32 v76, v76, v32, v33
v_max3_u32 v76, v76, v34, v35
v_permlane32_swap_b32 v32, v34
v_permlane32_swap_b32 v33, v35
v_and_b32 v68, s61, v34
v_and_b32 v69, s62, v34
v_and_b32 v72, s61, v35
v_and_b32 v73, s62, v35
v_dot2_f32_bf16 v68, v32, v68, 0
v_dot2_f32_bf16 v69, v32, v69, 0
v_dot2_f32_bf16 v72, v33, v72, 0
v_dot2_f32_bf16 v73, v33, v73, 0
s_nop 1
v_cvt_pk_bf16_f32 v66, v68, v69
v_cvt_pk_bf16_f32 v67, v72, v73
ds_write_b64 v12, v[66:67] offset:0
L_no80:
v_cmp_eq_u32 vcc, -1, v76
s_cmp_gt_u32 s56, 200000
s_cbranch_scc1 L_got0
s_cbranch_vccnz L_poll0
L_got0:
s_waitcnt lgkmcnt(0)
s_barrier
ds_read_b128 v[52:55], v9 offset:0
ds_read_b128 v[56:59], v10 offset:0
ds_read_b128 v[60:63], v11 offset:0
ds_read_b64 v[64:65], v12 offset:0
v_mfma_f32_16x16x32_bf16 v[80:83], v[100:103], v[48:51], 0
v_mfma_f32_16x16x32_bf16 v[84:87], v[118:121], v[48:51], 0
s_cmp_lg_u32 s53, 0
s_cbranch_scc1 L_n0a0
v_mfma_f32_16x16x32_bf16 v[88:91], v[136:139], v[48:51], 0
L_n0a0:
s_waitcnt lgkmcnt(3)
v_mfma_f32_16x16x32_bf16 v[80:83], v[104:107], v[52:55], v[80:83]
v_mfma_f32_16x16x32_bf16 v[84:87], v[122:125], v[52:55], v[84:87]
s_waitcnt lgkmcnt(2)
v_mfma_f32_16x16x32_bf16 v[80:83], v[108:111], v[56:59], v[80:83]
v_mfma_f32_16x16x32_bf16 v[84:87], v[126:129], v[56:59], v[84:87]
s_waitcnt lgkmcnt(1)
v_mfma_f32_16x16x32_bf16 v[80:83], v[112:115], v[60:63], v[80:83]
v_mfma_f32_16x16x32_bf16 v[84:87], v[130:133], v[60:63], v[84:87]
s_waitcnt lgkmcnt(0)
s_cbranch_scc1 L_n0b0
v_mfma_f32_16x16x32_bf16 v[88:91], v[140:143], v[52:55], v[88:91]
v_mfma_f32_16x16x32_bf16 v[88:91], v[144:147], v[56:59], v[88:91]
v_mfma_f32_16x16x32_bf16 v[88:91], v[148:151], v[60:63], v[88:91]
L_n0b0:
s_nop 3
v_mfma_f32_16x16x16_bf16 v[80:83], v[116:117], v[64:65], v[80:83]
v_mfma_f32_16x16x16_bf16 v[84:87], v[134:135], v[64:65], v[84:87]
s_cbranch_scc1 L_n0c0
s_nop 0
v_mfma_f32_16x16x16_bf16 v[88:91], v[152:153], v[64:65], v[88:91]
L_n0c0:
s_nop 6
v_cvt_pk_bf16_f32 v92, v80, v81
v_cvt_pk_bf16_f32 v93, v82, v83
v_cvt_pk_bf16_f32 v94, v84, v85
v_cvt_pk_bf16_f32 v95, v86, v87
buffer_store_dwordx4 v[92:95], v20, s[28:31], 0 offen nt
v_cvt_pk_bf16_f32 v96, v88, v89
v_cvt_pk_bf16_f32 v97, v90, v91
buffer_store_dwordx2 v[96:97], v22, s[28:31], 0 offen offset:256 nt
s_branch L_chk1
s_branch L_Ts6
L_ct6:
s_branch L_cr6
L_Ts6:
L_poll1:
buffer_load_dwordx4 v[36:39], v17, s[32:35], s65 offen offset:0 sc1
buffer_load_dwordx4 v[40:43], v17, s[32:35], s65 offen offset:1024 sc1
buffer_load_dwordx4 v[44:47], v18, s[32:35], s65 offen offset:2048 sc1
s_add_u32 s56, s56, 1
s_waitcnt vmcnt(0)
v_max_u32 v76, v36, v37
v_max3_u32 v76, v76, v38, v39
v_max3_u32 v76, v76, v40, v41
v_max3_u32 v76, v76, v42, v43
v_max3_u32 v76, v76, v44, v45
v_max3_u32 v76, v76, v46, v47
v_cmp_eq_u32 vcc, -1, v76
s_cmp_gt_u32 s56, 200000
s_cbranch_scc1 L_chk1
s_cbranch_vccnz L_poll1
L_chk1:
s_waitcnt vmcnt(4)
v_max3_u32 v76, v36, v37, v38
v_max_u32 v76, v76, v39
v_permlane32_swap_b32 v36, v38
v_permlane32_swap_b32 v37, v39
v_and_b32 v68, s61, v38
v_and_b32 v69, s62, v38
v_and_b32 v72, s61, v39
v_and_b32 v73, s62, v39
v_dot2_f32_bf16 v68, v36, v68, 0
v_dot2_f32_bf16 v69, v36, v69, 0
v_dot2_f32_bf16 v72, v37, v72, 0
v_dot2_f32_bf16 v73, v37, v73, 0
s_nop 1
v_cvt_pk_bf16_f32 v48, v68, v69
v_cvt_pk_bf16_f32 v49, v72, v73
s_waitcnt vmcnt(3)
v_max3_u32 v76, v76, v40, v41
v_max3_u32 v76, v76, v42, v43
v_permlane32_swap_b32 v40, v42
v_permlane32_swap_b32 v41, v43
v_and_b32 v68, s61, v42
v_and_b32 v69, s62, v42
v_and_b32 v72, s61, v43
v_and_b32 v73, s62, v43
v_dot2_f32_bf16 v68, v40, v68, 0
v_dot2_f32_bf16 v69, v40, v69, 0
v_dot2_f32_bf16 v72, v41, v72, 0
v_dot2_f32_bf16 v73, v41, v73, 0
s_nop 1
v_cvt_pk_bf16_f32 v50, v68, v69
v_cvt_pk_bf16_f32 v51, v72, v73
ds_write_b128 v8, v[48:51] offset:5120
s_cmp_lg_u32 s53, 3
s_cbranch_scc1 L_no81
s_waitcnt vmcnt(2)
v_max3_u32 v76, v76, v44, v45
v_max3_u32 v76, v76, v46, v47
v_permlane32_swap_b32 v44, v46
v_permlane32_swap_b32 v45, v47
v_and_b32 v68, s61, v46
v_and_b32 v69, s62, v46
v_and_b32 v72, s61, v47
v_and_b32 v73, s62, v47
v_dot2_f32_bf16 v68, v44, v68, 0
v_dot2_f32_bf16 v69, v44, v69, 0
v_dot2_f32_bf16 v72, v45, v72, 0
v_dot2_f32_bf16 v73, v45, v73, 0
s_nop 1
v_cvt_pk_bf16_f32 v66, v68, v69
v_cvt_pk_bf16_f32 v67, v72, v73
ds_write_b64 v12, v[66:67] offset:5120
L_no81:
v_cmp_eq_u32 vcc, -1, v76
s_cmp_gt_u32 s56, 200000
s_cbranch_scc1 L_got1
s_cbranch_vccnz L_poll1
L_got1:
s_waitcnt lgkmcnt(0)
s_barrier
ds_read_b128 v[52:55], v9 offset:5120
ds_read_b128 v[56:59], v10 offset:5120
ds_read_b128 v[60:63], v11 offset:5120
ds_read_b64 v[64:65], v12 offset:5120
v_mfma_f32_16x16x32_bf16 v[80:83], v[100:103], v[48:51], 0
v_mfma_f32_16x16x32_bf16 v[84:87], v[118:121], v[48:51], 0
s_cmp_lg_u32 s53, 0
s_cbranch_scc1 L_n0a1
v_mfma_f32_16x16x32_bf16 v[88:91], v[136:139], v[48:51], 0
L_n0a1:
s_waitcnt lgkmcnt(3)
v_mfma_f32_16x16x32_bf16 v[80:83], v[104:107], v[52:55], v[80:83]
v_mfma_f32_16x16x32_bf16 v[84:87], v[122:125], v[52:55], v[84:87]
s_waitcnt lgkmcnt(2)
v_mfma_f32_16x16x32_bf16 v[80:83], v[108:111], v[56:59], v[80:83]
v_mfma_f32_16x16x32_bf16 v[84:87], v[126:129], v[56:59], v[84:87]
s_waitcnt lgkmcnt(1)
v_mfma_f32_16x16x32_bf16 v[80:83], v[112:115], v[60:63], v[80:83]
v_mfma_f32_16x16x32_bf16 v[84:87], v[130:133], v[60:63], v[84:87]
s_waitcnt lgkmcnt(0)
s_cbranch_scc1 L_n0b1
v_mfma_f32_16x16x32_bf16 v[88:91], v[140:143], v[52:55], v[88:91]
v_mfma_f32_16x16x32_bf16 v[88:91], v[144:147], v[56:59], v[88:91]
v_mfma_f32_16x16x32_bf16 v[88:91], v[148:151], v[60:63], v[88:91]
L_n0b1:
s_nop 3
v_mfma_f32_16x16x16_bf16 v[80:83], v[116:117], v[64:65], v[80:83]
v_mfma_f32_16x16x16_bf16 v[84:87], v[134:135], v[64:65], v[84:87]
s_cbranch_scc1 L_n0c1
s_nop 0
v_mfma_f32_16x16x16_bf16 v[88:91], v[152:153], v[64:65], v[88:91]
L_n0c1:
s_nop 6
v_cvt_pk_bf16_f32 v92, v80, v81
v_cvt_pk_bf16_f32 v93, v82, v83
v_cvt_pk_bf16_f32 v94, v84, v85
v_cvt_pk_bf16_f32 v95, v86, v87
buffer_store_dwordx4 v[92:95], v21, s[28:31], 0 offen nt
v_cvt_pk_bf16_f32 v96, v88, v89
v_cvt_pk_bf16_f32 v97, v90, v91
buffer_store_dwordx2 v[96:97], v23, s[28:31], 0 offen offset:256 nt
s_branch L_Ts7
L_ct7:
s_branch L_cr7
L_Ts7:
s_endpgm
.p2align 12
L_C:
s_lshr_b32 s53, s44, 1
s_and_b32 s54, s44, 1
v_and_b32 v1, 15, v0
v_lshrrev_b32 v2, 4, v0
v_mul_u32_u24 v3, 2592, v1
s_mul_i32 s50, s53, 41472
v_add_u32 v3, s50, v3
v_lshl_add_u32 v48, v2, 4, v3
s_mov_b32 s52, 0
v_add_u32 v40, s52, v48
s_mov_b32 s52, 64
v_add_u32 v41, s52, v48
s_mov_b32 s52, 128
v_add_u32 v42, s52, v48
s_mov_b32 s52, 192
v_add_u32 v43, s52, v48
v_and_b32 v48, 1, v2
v_lshl_add_u32 v3, v48, 4, v3
v_lshrrev_b32 v49, 1, v2
v_mul_u32_u24 v49, 576, v49
v_sub_u32 v3, v3, v49
v_add_u32 v44, 832, v3
v_lshrrev_b32 v3, 2, v1
v_lshl_add_u32 v3, v2, 3, v3
v_lshlrev_b32 v3, 6, v3
v_and_b32 v49, 3, v0
v_lshl_add_u32 v3, v49, 3, v3
v_add_u32 v3, 92160, v3
v_xor_b32 v48, s54, v48
v_lshl_add_u32 v45, v48, 5, v3
s_lshl_b32 s50, s47, 1
s_add_u32 s50, s50, s54
s_cmp_lt_u32 s50, 9
s_mov_b32 s51, 0xbfb8aa3b
s_cselect_b32 s56, 0xc038aa3b, s51
s_cselect_b32 s57, 0.5, 1.0
s_cselect_b32 s52, 0x3eb17218, 0
v_mov_b32 v4, s52
v_mov_b32 v5, s52
v_mov_b32 v6, s52
v_mov_b32 v7, s52
v_mov_b32 v8, s52
v_mov_b32 v9, s52
v_mov_b32 v10, s52
v_mov_b32 v11, s52
v_mov_b32 v12, s52
v_mov_b32 v13, s52
v_mov_b32 v14, s52
v_mov_b32 v15, s52
v_mov_b32 v16, s52
v_mov_b32 v17, s52
v_mov_b32 v18, s52
v_mov_b32 v19, s52
v_mov_b32 v20, s52
v_mov_b32 v21, s52
v_mov_b32 v22, s52
v_mov_b32 v23, s52
v_mov_b32 v24, s52
v_mov_b32 v25, s52
v_mov_b32 v26, s52
v_mov_b32 v27, s52
v_mov_b32 v28, s52
v_mov_b32 v29, s52
v_mov_b32 v30, s52
v_mov_b32 v31, s52
v_mov_b32 v32, s52
v_mov_b32 v33, s52
v_mov_b32 v34, s52
v_mov_b32 v35, s52
v_mov_b32 v36, s52
v_mov_b32 v37, s52
v_mov_b32 v38, s52
v_mov_b32 v39, s52
s_cselect_b32 s51, -1.0, 0
v_mov_b32 v46, s51
v_and_b32 v48, 31, v0
v_lshrrev_b32 v49, 5, v0
v_lshlrev_b32 v48, 4, v48
v_lshl_add_u32 v47, v49, 3, v48
s_lshl_b32 s50, s50, 10
s_lshl_b32 s51, s53, 9
s_add_u32 s64, s50, s51
s_cmp_eq_u32 s53, 0
s_mov_b32 s51, 147456
s_cselect_b32 s51, 18432, s51
s_add_i32 s65, s64, s51
s_cmp_eq_u32 s53, 0
s_mov_b32 s51, 129024
s_cselect_b32 s51, 36864, s51
s_add_i32 s66, s64, s51
s_cmp_eq_u32 s53, 0
s_mov_b32 s51, 110592
s_cselect_b32 s51, 55296, s51
s_add_i32 s67, s64, s51
s_cmp_eq_u32 s53, 0
s_mov_b32 s51, 92160
s_cselect_b32 s51, 73728, s51
s_add_i32 s68, s64, s51
s_cmp_eq_u32 s53, 0
s_mov_b32 s51, 73728
s_cselect_b32 s51, 92160, s51
s_add_i32 s69, s64, s51
s_cmp_eq_u32 s53, 0
s_mov_b32 s51, 55296
s_cselect_b32 s51, 110592, s51
s_add_i32 s70, s64, s51
s_cmp_eq_u32 s53, 0
s_mov_b32 s51, 36864
s_cselect_b32 s51, 129024, s51
s_add_i32 s71, s64, s51
s_cmp_eq_u32 s53, 0
s_mov_b32 s51, 18432
s_cselect_b32 s51, 147456, s51
s_add_i32 s72, s64, s51
s_waitcnt lgkmcnt(0)
s_mul_i32 s51, s46, 165888
s_add_u32 s50, s14, s51
s_addc_u32 s51, s15, 0
s_mov_b32 s32, s50
s_and_b32 s33, s51, 0xffff
s_mov_b32 s34, 165888
s_mov_b32 s35, 0x20000
s_cmp_eq_u32 s44, 0
s_cbranch_scc1 L_ct0
s_cmp_eq_u32 s44, 1
s_cbranch_scc1 L_ct1
s_cmp_eq_u32 s44, 2
s_cbranch_scc1 L_ct2
s_cmp_eq_u32 s44, 3
s_cbranch_scc1 L_ct3
s_branch L_ctdone
L_cr0:
s_branch L_ctdone
L_cr1:
s_branch L_ctdone
L_cr2:
s_branch L_ctdone
L_cr3:
s_branch L_ctdone
L_ctdone:
s_lshl_b32 s50, s45, 2
s_add_u32 s50, s50, s44
s_lshl_b32 s50, s50, 10
v_lshl_add_u32 v1, v0, 4, s50
v_add_u32 v2, 1032192, v1
s_waitcnt lgkmcnt(0)
s_mov_b32 s20, s6
s_and_b32 s21, s7, 0xffff
s_mov_b32 s22, 1244160
s_mov_b32 s23, 0x20000
s_cmp_eq_u32 0, 1
s_barrier
ds_read_b64_tr_b16 v[60:61], v45 offset:0
ds_read_b64_tr_b16 v[62:63], v45 offset:256
ds_read_b128 v[64:67], v44 offset:10368
ds_read_b128 v[68:71], v44 offset:10080
ds_read_b128 v[72:75], v44 offset:9792
ds_read_b128 v[76:79], v44 offset:9504
ds_read_b128 v[80:83], v44 offset:9216
ds_read_b128 v[84:87], v44 offset:8928
ds_read_b128 v[88:91], v44 offset:8640
ds_read_b128 v[92:95], v44 offset:8352
ds_read_b128 v[96:99], v44 offset:8064
ds_read_b64_tr_b16 v[100:101], v45 offset:2048
ds_read_b64_tr_b16 v[102:103], v45 offset:2304
ds_read_b128 v[104:107], v44 offset:7776
buffer_load_dwordx4 v[56:59], v1, s[20:23], 0 offen
buffer_load_dwordx4 v[52:55], v2, s[20:23], 0 offen
s_waitcnt lgkmcnt(11)
v_mfma_f32_16x16x32_bf16 v[36:39], v[60:63], v[64:67], v[36:39]
ds_read_b128 v[64:67], v44 offset:7488
s_waitcnt lgkmcnt(11)
v_mfma_f32_16x16x32_bf16 v[32:35], v[60:63], v[68:71], v[32:35]
ds_read_b128 v[68:71], v44 offset:7200
s_waitcnt lgkmcnt(11)
v_mfma_f32_16x16x32_bf16 v[28:31], v[60:63], v[72:75], v[28:31]
ds_read_b128 v[72:75], v44 offset:6912
s_waitcnt lgkmcnt(11)
v_mfma_f32_16x16x32_bf16 v[24:27], v[60:63], v[76:79], v[24:27]
s_barrier
ds_read_b64_tr_b16 v[76:77], v45 offset:4096
s_waitcnt lgkmcnt(11)
v_mfma_f32_16x16x32_bf16 v[20:23], v[60:63], v[80:83], v[20:23]
ds_read_b64_tr_b16 v[78:79], v45 offset:4352
s_waitcnt lgkmcnt(11)
v_mfma_f32_16x16x32_bf16 v[16:19], v[60:63], v[84:87], v[16:19]
s_waitcnt lgkmcnt(10)
v_mfma_f32_16x16x32_bf16 v[12:15], v[60:63], v[88:91], v[12:15]
s_waitcnt lgkmcnt(9)
v_mfma_f32_16x16x32_bf16 v[8:11], v[60:63], v[92:95], v[8:11]
s_waitcnt lgkmcnt(8)
v_mfma_f32_16x16x32_bf16 v[4:7], v[60:63], v[96:99], v[4:7]
ds_read_b128 v[60:63], v44 offset:6624
s_waitcnt lgkmcnt(7)
v_mfma_f32_16x16x32_bf16 v[36:39], v[100:103], v[80:83], v[36:39]
ds_read_b128 v[80:83], v44 offset:6336
v_mfma_f32_16x16x32_bf16 v[32:35], v[100:103], v[84:87], v[32:35]
ds_read_b128 v[84:87], v44 offset:6048
v_mfma_f32_16x16x32_bf16 v[28:31], v[100:103], v[88:91], v[28:31]
ds_read_b128 v[88:91], v44 offset:5760
v_mfma_f32_16x16x32_bf16 v[24:27], v[100:103], v[92:95], v[24:27]
ds_read_b64_tr_b16 v[92:93], v45 offset:6144
v_mfma_f32_16x16x32_bf16 v[20:23], v[100:103], v[96:99], v[20:23]
ds_read_b64_tr_b16 v[94:95], v45 offset:6400
s_waitcnt lgkmcnt(6)
v_mfma_f32_16x16x32_bf16 v[16:19], v[100:103], v[104:107], v[16:19]
v_mfma_f32_16x16x32_bf16 v[12:15], v[100:103], v[64:67], v[12:15]
v_mfma_f32_16x16x32_bf16 v[8:11], v[100:103], v[68:71], v[8:11]
ds_read_b128 v[108:111], v44 offset:5472
v_mfma_f32_16x16x32_bf16 v[4:7], v[100:103], v[72:75], v[4:7]
ds_read_b128 v[100:103], v44 offset:5184
v_mfma_f32_16x16x32_bf16 v[36:39], v[76:79], v[96:99], v[36:39]
ds_read_b128 v[96:99], v44 offset:4896
v_mfma_f32_16x16x32_bf16 v[32:35], v[76:79], v[104:107], v[32:35]
ds_read_b128 v[104:107], v44 offset:4608
v_mfma_f32_16x16x32_bf16 v[28:31], v[76:79], v[64:67], v[28:31]
s_barrier
ds_read_b64_tr_b16 v[64:65], v45 offset:8192
v_mfma_f32_16x16x32_bf16 v[24:27], v[76:79], v[68:71], v[24:27]
ds_read_b64_tr_b16 v[66:67], v45 offset:8448
v_mfma_f32_16x16x32_bf16 v[20:23], v[76:79], v[72:75], v[20:23]
ds_read_b64_tr_b16 v[68:69], v45 offset:10240
s_waitcnt lgkmcnt(7)
v_mfma_f32_16x16x32_bf16 v[16:19], v[76:79], v[60:63], v[16:19]
ds_read_b64_tr_b16 v[70:71], v45 offset:10496
v_mfma_f32_16x16x32_bf16 v[12:15], v[76:79], v[80:83], v[12:15]
ds_read_b128 v[112:115], v44 offset:4032
v_mfma_f32_16x16x32_bf16 v[8:11], v[76:79], v[84:87], v[8:11]
v_mfma_f32_16x16x32_bf16 v[4:7], v[76:79], v[88:91], v[4:7]
v_mfma_f32_16x16x32_bf16 v[36:39], v[92:95], v[72:75], v[36:39]
ds_read_b128 v[72:75], v44 offset:3456
v_mfma_f32_16x16x32_bf16 v[32:35], v[92:95], v[60:63], v[32:35]
ds_read_b128 v[60:63], v44 offset:2880
v_mfma_f32_16x16x32_bf16 v[28:31], v[92:95], v[80:83], v[28:31]
v_mfma_f32_16x16x32_bf16 v[24:27], v[92:95], v[84:87], v[24:27]
v_mfma_f32_16x16x32_bf16 v[20:23], v[92:95], v[88:91], v[20:23]
ds_read_b128 v[76:79], v44 offset:2304
s_waitcnt lgkmcnt(3)
v_mfma_f32_16x16x32_bf16 v[16:19], v[92:95], v[108:111], v[16:19]
ds_read_b128 v[80:83], v44 offset:4320
v_mfma_f32_16x16x32_bf16 v[12:15], v[92:95], v[100:103], v[12:15]
v_mfma_f32_16x16x32_bf16 v[8:11], v[92:95], v[96:99], v[8:11]
v_mfma_f32_16x16x32_bf16 v[4:7], v[92:95], v[104:107], v[4:7]
ds_read_b128 v[84:87], v44 offset:3744
v_mfma_f32_16x16x32_bf16 v[36:39], v[64:67], v[88:91], v[36:39]
ds_read_b128 v[88:91], v44 offset:3168
v_mfma_f32_16x16x32_bf16 v[36:39], v[68:71], v[104:107], v[36:39]
ds_read_b128 v[92:95], v44 offset:2592
v_mfma_f32_16x16x32_bf16 v[28:31], v[68:71], v[112:115], v[28:31]
s_barrier
ds_read_b64_tr_b16 v[116:117], v45 offset:12288
v_mfma_f32_16x16x32_bf16 v[28:31], v[64:67], v[100:103], v[28:31]
ds_read_b64_tr_b16 v[118:119], v45 offset:12544
v_mfma_f32_16x16x32_bf16 v[20:23], v[64:67], v[104:107], v[20:23]
ds_read_b64_tr_b16 v[100:101], v45 offset:14336
s_waitcnt lgkmcnt(6)
v_mfma_f32_16x16x32_bf16 v[20:23], v[68:71], v[72:75], v[20:23]
ds_read_b64_tr_b16 v[102:103], v45 offset:14592
v_mfma_f32_16x16x32_bf16 v[12:15], v[68:71], v[60:63], v[12:15]
ds_read_b128 v[104:107], v44 offset:1728
v_mfma_f32_16x16x32_bf16 v[12:15], v[64:67], v[112:115], v[12:15]
v_mfma_f32_16x16x32_bf16 v[4:7], v[64:67], v[72:75], v[4:7]
v_mfma_f32_16x16x32_bf16 v[4:7], v[68:71], v[76:79], v[4:7]
ds_read_b128 v[112:115], v44 offset:1152
v_mfma_f32_16x16x32_bf16 v[32:35], v[68:71], v[80:83], v[32:35]
ds_read_b128 v[120:123], v44 offset:576
v_mfma_f32_16x16x32_bf16 v[32:35], v[64:67], v[108:111], v[32:35]
v_mfma_f32_16x16x32_bf16 v[24:27], v[64:67], v[96:99], v[24:27]
ds_read_b128 v[96:99], v44 offset:0
s_waitcnt lgkmcnt(4)
v_mfma_f32_16x16x32_bf16 v[24:27], v[68:71], v[84:87], v[24:27]
ds_read_b128 v[108:111], v44 offset:2016
v_mfma_f32_16x16x32_bf16 v[16:19], v[68:71], v[88:91], v[16:19]
v_mfma_f32_16x16x32_bf16 v[16:19], v[64:67], v[80:83], v[16:19]
ds_read_b128 v[80:83], v44 offset:1440
v_mfma_f32_16x16x32_bf16 v[8:11], v[64:67], v[84:87], v[8:11]
ds_read_b128 v[64:67], v44 offset:864
v_mfma_f32_16x16x32_bf16 v[8:11], v[68:71], v[92:95], v[8:11]
ds_read_b128 v[68:71], v44 offset:288
v_mfma_f32_16x16x32_bf16 v[36:39], v[116:119], v[72:75], v[36:39]
ds_read_b128 v[72:75], v40 offset:10944
v_mfma_f32_16x16x32_bf16 v[36:39], v[100:103], v[76:79], v[36:39]
s_barrier
ds_read_b64_tr_b16 v[84:85], v45 offset:16384
s_waitcnt lgkmcnt(6)
v_mfma_f32_16x16x32_bf16 v[28:31], v[100:103], v[104:107], v[28:31]
ds_read_b64_tr_b16 v[86:87], v45 offset:16640
v_mfma_f32_16x16x32_bf16 v[28:31], v[116:119], v[60:63], v[28:31]
ds_read_b128 v[60:63], v40 offset:10368
v_mfma_f32_16x16x32_bf16 v[20:23], v[116:119], v[76:79], v[20:23]
ds_read_b64_tr_b16 v[76:77], v45 offset:18432
v_mfma_f32_16x16x32_bf16 v[20:23], v[100:103], v[112:115], v[20:23]
ds_read_b64_tr_b16 v[78:79], v45 offset:18688
v_mfma_f32_16x16x32_bf16 v[12:15], v[100:103], v[120:123], v[12:15]
ds_read_b128 v[120:123], v40 offset:9792
v_mfma_f32_16x16x32_bf16 v[12:15], v[116:119], v[104:107], v[12:15]
v_mfma_f32_16x16x32_bf16 v[4:7], v[116:119], v[112:115], v[4:7]
v_mfma_f32_16x16x32_bf16 v[4:7], v[100:103], v[96:99], v[4:7]
ds_read_b128 v[96:99], v40 offset:9216
s_waitcnt lgkmcnt(5)
v_mfma_f32_16x16x32_bf16 v[32:35], v[100:103], v[108:111], v[32:35]
ds_read_b128 v[104:107], v40 offset:8640
v_mfma_f32_16x16x32_bf16 v[32:35], v[116:119], v[88:91], v[32:35]
v_mfma_f32_16x16x32_bf16 v[24:27], v[116:119], v[92:95], v[24:27]
ds_read_b128 v[88:91], v40 offset:8064
v_mfma_f32_16x16x32_bf16 v[24:27], v[100:103], v[80:83], v[24:27]
v_mfma_f32_16x16x32_bf16 v[16:19], v[100:103], v[64:67], v[16:19]
ds_read_b128 v[64:67], v40 offset:10080
v_mfma_f32_16x16x32_bf16 v[16:19], v[116:119], v[108:111], v[16:19]
ds_read_b128 v[92:95], v40 offset:10656
v_mfma_f32_16x16x32_bf16 v[8:11], v[116:119], v[80:83], v[8:11]
ds_read_b128 v[80:83], v40 offset:9504
v_mfma_f32_16x16x32_bf16 v[8:11], v[100:103], v[68:71], v[8:11]
ds_read_b128 v[68:71], v40 offset:8928
v_mfma_f32_16x16x32_bf16 v[36:39], v[84:87], v[72:75], v[36:39]
ds_read_b128 v[72:75], v40 offset:8352
s_waitcnt lgkmcnt(6)
v_mfma_f32_16x16x32_bf16 v[36:39], v[76:79], v[60:63], v[36:39]
s_barrier
ds_read_b64_tr_b16 v[100:101], v45 offset:20480
v_mfma_f32_16x16x32_bf16 v[28:31], v[76:79], v[120:123], v[28:31]
ds_read_b64_tr_b16 v[102:103], v45 offset:20736
v_mfma_f32_16x16x32_bf16 v[28:31], v[84:87], v[60:63], v[28:31]
ds_read_b64_tr_b16 v[60:61], v45 offset:22528
v_mfma_f32_16x16x32_bf16 v[20:23], v[84:87], v[120:123], v[20:23]
ds_read_b64_tr_b16 v[62:63], v45 offset:22784
v_mfma_f32_16x16x32_bf16 v[20:23], v[76:79], v[96:99], v[20:23]
ds_read_b64_tr_b16 v[108:109], v45 offset:24576
v_mfma_f32_16x16x32_bf16 v[12:15], v[76:79], v[104:107], v[12:15]
ds_read_b64_tr_b16 v[110:111], v45 offset:24832
v_mfma_f32_16x16x32_bf16 v[12:15], v[84:87], v[96:99], v[12:15]
v_mfma_f32_16x16x32_bf16 v[4:7], v[84:87], v[104:107], v[4:7]
s_waitcnt lgkmcnt(5)
v_mfma_f32_16x16x32_bf16 v[4:7], v[76:79], v[88:91], v[4:7]
v_mfma_f32_16x16x32_bf16 v[32:35], v[76:79], v[64:67], v[32:35]
v_mfma_f32_16x16x32_bf16 v[32:35], v[84:87], v[92:95], v[32:35]
v_mfma_f32_16x16x32_bf16 v[24:27], v[84:87], v[64:67], v[24:27]
ds_read_b128 v[64:67], v40 offset:7488
v_mfma_f32_16x16x32_bf16 v[24:27], v[76:79], v[80:83], v[24:27]
ds_read_b128 v[92:95], v40 offset:6912
v_mfma_f32_16x16x32_bf16 v[16:19], v[76:79], v[68:71], v[16:19]
v_mfma_f32_16x16x32_bf16 v[16:19], v[84:87], v[80:83], v[16:19]
v_mfma_f32_16x16x32_bf16 v[8:11], v[84:87], v[68:71], v[8:11]
v_mfma_f32_16x16x32_bf16 v[8:11], v[76:79], v[72:75], v[8:11]
s_waitcnt lgkmcnt(2)
v_mfma_f32_16x16x32_bf16 v[36:39], v[100:103], v[120:123], v[36:39]
ds_read_b128 v[76:79], v40 offset:6336
v_mfma_f32_16x16x32_bf16 v[36:39], v[60:63], v[96:99], v[36:39]
v_mfma_f32_16x16x32_bf16 v[36:39], v[108:111], v[104:107], v[36:39]
v_mfma_f32_16x16x32_bf16 v[28:31], v[108:111], v[88:91], v[28:31]
v_mfma_f32_16x16x32_bf16 v[28:31], v[60:63], v[104:107], v[28:31]
ds_read_b128 v[84:87], v40 offset:7776
v_mfma_f32_16x16x32_bf16 v[28:31], v[100:103], v[96:99], v[28:31]
ds_read_b128 v[96:99], v40 offset:7200
v_mfma_f32_16x16x32_bf16 v[20:23], v[100:103], v[104:107], v[20:23]
ds_read_b128 v[104:107], v40 offset:6624
v_mfma_f32_16x16x32_bf16 v[20:23], v[60:63], v[88:91], v[20:23]
ds_read_b64_tr_b16 v[112:113], v45 offset:26624
s_waitcnt lgkmcnt(4)
v_mfma_f32_16x16x32_bf16 v[20:23], v[108:111], v[64:67], v[20:23]
ds_read_b64_tr_b16 v[114:115], v45 offset:26880
v_mfma_f32_16x16x32_bf16 v[12:15], v[108:111], v[92:95], v[12:15]
s_barrier
ds_read_b64_tr_b16 v[116:117], v45 offset:28672
v_mfma_f32_16x16x32_bf16 v[12:15], v[60:63], v[64:67], v[12:15]
ds_read_b64_tr_b16 v[118:119], v45 offset:28928
v_mfma_f32_16x16x32_bf16 v[12:15], v[100:103], v[88:91], v[12:15]
ds_read_b64_tr_b16 v[120:121], v45 offset:30720
v_mfma_f32_16x16x32_bf16 v[4:7], v[100:103], v[64:67], v[4:7]
ds_read_b64_tr_b16 v[122:123], v45 offset:30976
v_mfma_f32_16x16x32_bf16 v[4:7], v[60:63], v[92:95], v[4:7]
ds_read_b64_tr_b16 v[124:125], v45 offset:32768
v_mfma_f32_16x16x32_bf16 v[4:7], v[108:111], v[76:79], v[4:7]
ds_read_b64_tr_b16 v[126:127], v45 offset:33024
v_mfma_f32_16x16x32_bf16 v[32:35], v[108:111], v[72:75], v[32:35]
ds_read_b128 v[128:131], v40 offset:5760
v_mfma_f32_16x16x32_bf16 v[32:35], v[60:63], v[68:71], v[32:35]
ds_read_b64_tr_b16 v[132:133], v45 offset:34816
v_mfma_f32_16x16x32_bf16 v[32:35], v[100:103], v[80:83], v[32:35]
ds_read_b64_tr_b16 v[134:135], v45 offset:35072
v_mfma_f32_16x16x32_bf16 v[24:27], v[100:103], v[68:71], v[24:27]
ds_read_b128 v[68:71], v40 offset:5184
v_mfma_f32_16x16x32_bf16 v[24:27], v[60:63], v[72:75], v[24:27]
s_waitcnt lgkmcnt(6)
v_mfma_f32_16x16x32_bf16 v[24:27], v[108:111], v[84:87], v[24:27]
v_mfma_f32_16x16x32_bf16 v[16:19], v[108:111], v[96:99], v[16:19]
v_mfma_f32_16x16x32_bf16 v[16:19], v[60:63], v[84:87], v[16:19]
v_mfma_f32_16x16x32_bf16 v[16:19], v[100:103], v[72:75], v[16:19]
v_mfma_f32_16x16x32_bf16 v[8:11], v[100:103], v[84:87], v[8:11]
v_mfma_f32_16x16x32_bf16 v[8:11], v[60:63], v[96:99], v[8:11]
v_mfma_f32_16x16x32_bf16 v[8:11], v[108:111], v[104:107], v[8:11]
v_mfma_f32_16x16x32_bf16 v[36:39], v[112:115], v[88:91], v[36:39]
ds_read_b128 v[60:63], v40 offset:4608
v_mfma_f32_16x16x32_bf16 v[36:39], v[116:119], v[64:67], v[36:39]
ds_read_b128 v[72:75], v40 offset:4032
v_mfma_f32_16x16x32_bf16 v[36:39], v[120:123], v[92:95], v[36:39]
s_waitcnt lgkmcnt(2)
v_mfma_f32_16x16x32_bf16 v[36:39], v[124:127], v[76:79], v[36:39]
v_mfma_f32_16x16x32_bf16 v[36:39], v[132:135], v[128:131], v[36:39]
v_mfma_f32_16x16x32_bf16 v[28:31], v[132:135], v[68:71], v[28:31]
v_mfma_f32_16x16x32_bf16 v[28:31], v[124:127], v[128:131], v[28:31]
v_mfma_f32_16x16x32_bf16 v[28:31], v[120:123], v[76:79], v[28:31]
v_mfma_f32_16x16x32_bf16 v[28:31], v[116:119], v[92:95], v[28:31]
v_mfma_f32_16x16x32_bf16 v[28:31], v[112:115], v[64:67], v[28:31]
v_mfma_f32_16x16x32_bf16 v[20:23], v[112:115], v[92:95], v[20:23]
ds_read_b128 v[64:67], v40 offset:3456
v_mfma_f32_16x16x32_bf16 v[20:23], v[116:119], v[76:79], v[20:23]
ds_read_b128 v[80:83], v40 offset:5472
v_mfma_f32_16x16x32_bf16 v[20:23], v[120:123], v[128:131], v[20:23]
ds_read_b128 v[88:91], v40 offset:6048
v_mfma_f32_16x16x32_bf16 v[20:23], v[124:127], v[68:71], v[20:23]
s_waitcnt lgkmcnt(3)
v_mfma_f32_16x16x32_bf16 v[20:23], v[132:135], v[60:63], v[20:23]
v_mfma_f32_16x16x32_bf16 v[12:15], v[132:135], v[72:75], v[12:15]
v_mfma_f32_16x16x32_bf16 v[12:15], v[124:127], v[60:63], v[12:15]
v_mfma_f32_16x16x32_bf16 v[12:15], v[120:123], v[68:71], v[12:15]
v_mfma_f32_16x16x32_bf16 v[12:15], v[116:119], v[128:131], v[12:15]
v_mfma_f32_16x16x32_bf16 v[12:15], v[112:115], v[76:79], v[12:15]
v_mfma_f32_16x16x32_bf16 v[4:7], v[112:115], v[128:131], v[4:7]
ds_read_b128 v[76:79], v40 offset:4896
v_mfma_f32_16x16x32_bf16 v[4:7], v[116:119], v[68:71], v[4:7]
ds_read_b128 v[92:95], v40 offset:4320
v_mfma_f32_16x16x32_bf16 v[4:7], v[120:123], v[60:63], v[4:7]
v_mfma_f32_16x16x32_bf16 v[4:7], v[124:127], v[72:75], v[4:7]
s_waitcnt lgkmcnt(2)
v_mfma_f32_16x16x32_bf16 v[4:7], v[132:135], v[64:67], v[4:7]
ds_read_b128 v[100:103], v40 offset:3744
v_mfma_f32_16x16x32_bf16 v[32:35], v[132:135], v[80:83], v[32:35]
s_barrier
ds_read_b64_tr_b16 v[108:109], v45 offset:36864
v_mfma_f32_16x16x32_bf16 v[32:35], v[124:127], v[88:91], v[32:35]
ds_read_b64_tr_b16 v[110:111], v45 offset:37120
v_mfma_f32_16x16x32_bf16 v[32:35], v[120:123], v[104:107], v[32:35]
ds_read_b64_tr_b16 v[128:129], v45 offset:38912
v_mfma_f32_16x16x32_bf16 v[32:35], v[116:119], v[96:99], v[32:35]
ds_read_b64_tr_b16 v[130:131], v45 offset:39168
v_mfma_f32_16x16x32_bf16 v[32:35], v[112:115], v[84:87], v[32:35]
ds_read_b64_tr_b16 v[84:85], v45 offset:40960
v_mfma_f32_16x16x32_bf16 v[24:27], v[112:115], v[96:99], v[24:27]
ds_read_b64_tr_b16 v[86:87], v45 offset:41216
v_mfma_f32_16x16x32_bf16 v[24:27], v[116:119], v[104:107], v[24:27]
ds_read_b64_tr_b16 v[96:97], v45 offset:43008
v_mfma_f32_16x16x32_bf16 v[24:27], v[120:123], v[88:91], v[24:27]
ds_read_b64_tr_b16 v[98:99], v45 offset:43264
v_mfma_f32_16x16x32_bf16 v[24:27], v[124:127], v[80:83], v[24:27]
ds_read_b128 v[136:139], v40 offset:2880
s_waitcnt lgkmcnt(7)
v_mfma_f32_16x16x32_bf16 v[24:27], v[132:135], v[76:79], v[24:27]
ds_read_b64_tr_b16 v[140:141], v45 offset:45056
v_mfma_f32_16x16x32_bf16 v[16:19], v[132:135], v[92:95], v[16:19]
ds_read_b64_tr_b16 v[142:143], v45 offset:45312
v_mfma_f32_16x16x32_bf16 v[16:19], v[124:127], v[76:79], v[16:19]
ds_read_b128 v[144:147], v40 offset:2304
v_mfma_f32_16x16x32_bf16 v[16:19], v[120:123], v[80:83], v[16:19]
v_mfma_f32_16x16x32_bf16 v[16:19], v[116:119], v[88:91], v[16:19]
v_mfma_f32_16x16x32_bf16 v[16:19], v[112:115], v[104:107], v[16:19]
v_mfma_f32_16x16x32_bf16 v[8:11], v[112:115], v[88:91], v[8:11]
v_mfma_f32_16x16x32_bf16 v[8:11], v[116:119], v[80:83], v[8:11]
v_mfma_f32_16x16x32_bf16 v[8:11], v[120:123], v[76:79], v[8:11]
v_mfma_f32_16x16x32_bf16 v[8:11], v[124:127], v[92:95], v[8:11]
v_mfma_f32_16x16x32_bf16 v[8:11], v[132:135], v[100:103], v[8:11]
v_mfma_f32_16x16x32_bf16 v[36:39], v[108:111], v[68:71], v[36:39]
ds_read_b128 v[68:71], v40 offset:1728
s_waitcnt lgkmcnt(1)
v_mfma_f32_16x16x32_bf16 v[36:39], v[128:131], v[60:63], v[36:39]
ds_read_b128 v[80:83], v40 offset:1152
v_mfma_f32_16x16x32_bf16 v[36:39], v[84:87], v[72:75], v[36:39]
v_mfma_f32_16x16x32_bf16 v[36:39], v[96:99], v[64:67], v[36:39]
v_mfma_f32_16x16x32_bf16 v[36:39], v[140:143], v[136:139], v[36:39]
v_mfma_f32_16x16x32_bf16 v[28:31], v[140:143], v[144:147], v[28:31]
v_mfma_f32_16x16x32_bf16 v[28:31], v[96:99], v[136:139], v[28:31]
v_mfma_f32_16x16x32_bf16 v[28:31], v[84:87], v[64:67], v[28:31]
v_mfma_f32_16x16x32_bf16 v[28:31], v[128:131], v[72:75], v[28:31]
v_mfma_f32_16x16x32_bf16 v[28:31], v[108:111], v[60:63], v[28:31]
v_mfma_f32_16x16x32_bf16 v[20:23], v[108:111], v[72:75], v[20:23]
ds_read_b128 v[60:63], v40 offset:576
v_mfma_f32_16x16x32_bf16 v[20:23], v[128:131], v[64:67], v[20:23]
ds_read_b128 v[72:75], v40 offset:2592
v_mfma_f32_16x16x32_bf16 v[20:23], v[84:87], v[136:139], v[20:23]
ds_read_b128 v[88:91], v40 offset:3168
v_mfma_f32_16x16x32_bf16 v[20:23], v[96:99], v[144:147], v[20:23]
s_waitcnt lgkmcnt(3)
v_mfma_f32_16x16x32_bf16 v[20:23], v[140:143], v[68:71], v[20:23]
v_mfma_f32_16x16x32_bf16 v[12:15], v[140:143], v[80:83], v[12:15]
v_mfma_f32_16x16x32_bf16 v[12:15], v[96:99], v[68:71], v[12:15]
v_mfma_f32_16x16x32_bf16 v[12:15], v[84:87], v[144:147], v[12:15]
v_mfma_f32_16x16x32_bf16 v[12:15], v[128:131], v[136:139], v[12:15]
ds_read_b128 v[104:107], v40 offset:2016
v_mfma_f32_16x16x32_bf16 v[12:15], v[108:111], v[64:67], v[12:15]
ds_read_b128 v[64:67], v40 offset:1440
v_mfma_f32_16x16x32_bf16 v[4:7], v[108:111], v[136:139], v[4:7]
ds_read_b128 v[112:115], v40 offset:864
v_mfma_f32_16x16x32_bf16 v[4:7], v[128:131], v[144:147], v[4:7]
ds_read_b128 v[116:119], v41 offset:10944
v_mfma_f32_16x16x32_bf16 v[4:7], v[84:87], v[68:71], v[4:7]
ds_read_b64_tr_b16 v[68:69], v45 offset:47104
v_mfma_f32_16x16x32_bf16 v[4:7], v[96:99], v[80:83], v[4:7]
ds_read_b64_tr_b16 v[70:71], v45 offset:47360
s_waitcnt lgkmcnt(6)
v_mfma_f32_16x16x32_bf16 v[4:7], v[140:143], v[60:63], v[4:7]
ds_read_b128 v[60:63], v41 offset:10368
v_mfma_f32_16x16x32_bf16 v[32:35], v[140:143], v[72:75], v[32:35]
s_barrier
ds_read_b64_tr_b16 v[80:81], v45 offset:49152
v_mfma_f32_16x16x32_bf16 v[32:35], v[96:99], v[88:91], v[32:35]
ds_read_b64_tr_b16 v[82:83], v45 offset:49408
v_mfma_f32_16x16x32_bf16 v[32:35], v[84:87], v[100:103], v[32:35]
ds_read_b128 v[120:123], v41 offset:9792
v_mfma_f32_16x16x32_bf16 v[32:35], v[128:131], v[92:95], v[32:35]
ds_read_b64_tr_b16 v[124:125], v45 offset:51200
v_mfma_f32_16x16x32_bf16 v[32:35], v[108:111], v[76:79], v[32:35]
ds_read_b64_tr_b16 v[126:127], v45 offset:51456
v_mfma_f32_16x16x32_bf16 v[24:27], v[108:111], v[92:95], v[24:27]
ds_read_b128 v[76:79], v41 offset:9216
v_mfma_f32_16x16x32_bf16 v[24:27], v[128:131], v[100:103], v[24:27]
ds_read_b64_tr_b16 v[92:93], v45 offset:53248
v_mfma_f32_16x16x32_bf16 v[24:27], v[84:87], v[88:91], v[24:27]
ds_read_b64_tr_b16 v[94:95], v45 offset:53504
v_mfma_f32_16x16x32_bf16 v[24:27], v[96:99], v[72:75], v[24:27]
ds_read_b128 v[132:135], v41 offset:8640
s_waitcnt lgkmcnt(7)
v_mfma_f32_16x16x32_bf16 v[24:27], v[140:143], v[104:107], v[24:27]
ds_read_b64_tr_b16 v[136:137], v45 offset:55296
v_mfma_f32_16x16x32_bf16 v[16:19], v[140:143], v[64:67], v[16:19]
ds_read_b64_tr_b16 v[138:139], v45 offset:55552
v_mfma_f32_16x16x32_bf16 v[16:19], v[96:99], v[104:107], v[16:19]
ds_read_b128 v[144:147], v41 offset:8064
v_mfma_f32_16x16x32_bf16 v[16:19], v[84:87], v[72:75], v[16:19]
v_mfma_f32_16x16x32_bf16 v[16:19], v[128:131], v[88:91], v[16:19]
v_mfma_f32_16x16x32_bf16 v[16:19], v[108:111], v[100:103], v[16:19]
v_mfma_f32_16x16x32_bf16 v[8:11], v[108:111], v[88:91], v[8:11]
v_mfma_f32_16x16x32_bf16 v[8:11], v[128:131], v[72:75], v[8:11]
v_mfma_f32_16x16x32_bf16 v[8:11], v[84:87], v[104:107], v[8:11]
v_mfma_f32_16x16x32_bf16 v[8:11], v[96:99], v[64:67], v[8:11]
v_mfma_f32_16x16x32_bf16 v[8:11], v[140:143], v[112:115], v[8:11]
v_mfma_f32_16x16x32_bf16 v[36:39], v[68:71], v[116:119], v[36:39]
ds_read_b128 v[64:67], v41 offset:7488
v_mfma_f32_16x16x32_bf16 v[36:39], v[80:83], v[60:63], v[36:39]
ds_read_b128 v[72:75], v41 offset:6912
s_waitcnt lgkmcnt(2)
v_mfma_f32_16x16x32_bf16 v[36:39], v[124:127], v[120:123], v[36:39]
v_mfma_f32_16x16x32_bf16 v[36:39], v[92:95], v[76:79], v[36:39]
v_mfma_f32_16x16x32_bf16 v[36:39], v[136:139], v[132:135], v[36:39]
v_mfma_f32_16x16x32_bf16 v[28:31], v[136:139], v[144:147], v[28:31]
v_mfma_f32_16x16x32_bf16 v[28:31], v[92:95], v[132:135], v[28:31]
v_mfma_f32_16x16x32_bf16 v[28:31], v[124:127], v[76:79], v[28:31]
v_mfma_f32_16x16x32_bf16 v[28:31], v[80:83], v[120:123], v[28:31]
v_mfma_f32_16x16x32_bf16 v[28:31], v[68:71], v[60:63], v[28:31]
v_mfma_f32_16x16x32_bf16 v[20:23], v[68:71], v[120:123], v[20:23]
ds_read_b128 v[60:63], v41 offset:6336
v_mfma_f32_16x16x32_bf16 v[20:23], v[80:83], v[76:79], v[20:23]
ds_read_b128 v[84:87], v41 offset:8352
v_mfma_f32_16x16x32_bf16 v[20:23], v[124:127], v[132:135], v[20:23]
ds_read_b128 v[88:91], v41 offset:8928
v_mfma_f32_16x16x32_bf16 v[20:23], v[92:95], v[144:147], v[20:23]
ds_read_b128 v[96:99], v41 offset:9504
s_waitcnt lgkmcnt(4)
v_mfma_f32_16x16x32_bf16 v[20:23], v[136:139], v[64:67], v[20:23]
ds_read_b128 v[100:103], v41 offset:10080
v_mfma_f32_16x16x32_bf16 v[12:15], v[136:139], v[72:75], v[12:15]
ds_read_b128 v[104:107], v41 offset:10656
v_mfma_f32_16x16x32_bf16 v[12:15], v[92:95], v[64:67], v[12:15]
v_mfma_f32_16x16x32_bf16 v[12:15], v[124:127], v[144:147], v[12:15]
v_mfma_f32_16x16x32_bf16 v[12:15], v[80:83], v[132:135], v[12:15]
v_mfma_f32_16x16x32_bf16 v[12:15], v[68:71], v[76:79], v[12:15]
v_mfma_f32_16x16x32_bf16 v[4:7], v[68:71], v[132:135], v[4:7]
ds_read_b128 v[76:79], v41 offset:7776
v_mfma_f32_16x16x32_bf16 v[4:7], v[80:83], v[144:147], v[4:7]
ds_read_b128 v[108:111], v41 offset:7200
v_mfma_f32_16x16x32_bf16 v[4:7], v[124:127], v[64:67], v[4:7]
v_mfma_f32_16x16x32_bf16 v[4:7], v[92:95], v[72:75], v[4:7]
s_waitcnt lgkmcnt(2)
v_mfma_f32_16x16x32_bf16 v[4:7], v[136:139], v[60:63], v[4:7]
ds_read_b128 v[112:115], v41 offset:6624
v_mfma_f32_16x16x32_bf16 v[32:35], v[136:139], v[84:87], v[32:35]
ds_read_b64_tr_b16 v[116:117], v45 offset:57344
v_mfma_f32_16x16x32_bf16 v[32:35], v[92:95], v[88:91], v[32:35]
ds_read_b64_tr_b16 v[118:119], v45 offset:57600
v_mfma_f32_16x16x32_bf16 v[32:35], v[124:127], v[96:99], v[32:35]
ds_read_b64_tr_b16 v[120:121], v45 offset:59392
v_mfma_f32_16x16x32_bf16 v[32:35], v[80:83], v[100:103], v[32:35]
ds_read_b64_tr_b16 v[122:123], v45 offset:59648
v_mfma_f32_16x16x32_bf16 v[32:35], v[68:71], v[104:107], v[32:35]
ds_read_b64_tr_b16 v[104:105], v45 offset:61440
v_mfma_f32_16x16x32_bf16 v[24:27], v[68:71], v[100:103], v[24:27]
ds_read_b64_tr_b16 v[106:107], v45 offset:61696
v_mfma_f32_16x16x32_bf16 v[24:27], v[80:83], v[96:99], v[24:27]
ds_read_b64_tr_b16 v[100:101], v45 offset:63488
v_mfma_f32_16x16x32_bf16 v[24:27], v[124:127], v[88:91], v[24:27]
ds_read_b64_tr_b16 v[102:103], v45 offset:63744
v_mfma_f32_16x16x32_bf16 v[24:27], v[92:95], v[84:87], v[24:27]
L_ct0:
s_cbranch_scc1 L_cr0
ds_read_b128 v[128:131], v41 offset:5760
s_waitcnt lgkmcnt(7)
v_mfma_f32_16x16x32_bf16 v[24:27], v[136:139], v[76:79], v[24:27]
ds_read_b64_tr_b16 v[132:133], v45 offset:0
v_mfma_f32_16x16x32_bf16 v[16:19], v[136:139], v[108:111], v[16:19]
ds_read_b64_tr_b16 v[134:135], v45 offset:256
v_mfma_f32_16x16x32_bf16 v[16:19], v[92:95], v[76:79], v[16:19]
ds_read_b128 v[140:143], v41 offset:5184
v_mfma_f32_16x16x32_bf16 v[16:19], v[124:127], v[84:87], v[16:19]
v_mfma_f32_16x16x32_bf16 v[16:19], v[80:83], v[88:91], v[16:19]
v_mfma_f32_16x16x32_bf16 v[16:19], v[68:71], v[96:99], v[16:19]
v_mfma_f32_16x16x32_bf16 v[8:11], v[68:71], v[88:91], v[8:11]
v_mfma_f32_16x16x32_bf16 v[8:11], v[80:83], v[84:87], v[8:11]
v_mfma_f32_16x16x32_bf16 v[8:11], v[124:127], v[76:79], v[8:11]
v_mfma_f32_16x16x32_bf16 v[8:11], v[92:95], v[108:111], v[8:11]
v_mfma_f32_16x16x32_bf16 v[8:11], v[136:139], v[112:115], v[8:11]
v_mfma_f32_16x16x32_bf16 v[36:39], v[116:119], v[144:147], v[36:39]
ds_read_b128 v[68:71], v41 offset:4608
s_waitcnt lgkmcnt(1)
v_mfma_f32_16x16x32_bf16 v[36:39], v[120:123], v[64:67], v[36:39]
ds_read_b128 v[80:83], v41 offset:4032
v_mfma_f32_16x16x32_bf16 v[36:39], v[104:107], v[72:75], v[36:39]
v_mfma_f32_16x16x32_bf16 v[36:39], v[100:103], v[60:63], v[36:39]
v_mfma_f32_16x16x32_bf16 v[36:39], v[132:135], v[128:131], v[36:39]
v_mfma_f32_16x16x32_bf16 v[28:31], v[132:135], v[140:143], v[28:31]
v_mfma_f32_16x16x32_bf16 v[28:31], v[100:103], v[128:131], v[28:31]
v_mfma_f32_16x16x32_bf16 v[28:31], v[104:107], v[60:63], v[28:31]
v_mfma_f32_16x16x32_bf16 v[28:31], v[120:123], v[72:75], v[28:31]
v_mfma_f32_16x16x32_bf16 v[28:31], v[116:119], v[64:67], v[28:31]
v_mfma_f32_16x16x32_bf16 v[20:23], v[116:119], v[72:75], v[20:23]
ds_read_b128 v[64:67], v41 offset:3456
v_mfma_f32_16x16x32_bf16 v[20:23], v[120:123], v[60:63], v[20:23]
ds_read_b128 v[72:75], v41 offset:5472
v_mfma_f32_16x16x32_bf16 v[20:23], v[104:107], v[128:131], v[20:23]
ds_read_b128 v[84:87], v41 offset:6048
v_mfma_f32_16x16x32_bf16 v[20:23], v[100:103], v[140:143], v[20:23]
s_waitcnt lgkmcnt(3)
v_mfma_f32_16x16x32_bf16 v[20:23], v[132:135], v[68:71], v[20:23]
v_mfma_f32_16x16x32_bf16 v[12:15], v[132:135], v[80:83], v[12:15]
v_mfma_f32_16x16x32_bf16 v[12:15], v[100:103], v[68:71], v[12:15]
v_mfma_f32_16x16x32_bf16 v[12:15], v[104:107], v[140:143], v[12:15]
v_mfma_f32_16x16x32_bf16 v[12:15], v[120:123], v[128:131], v[12:15]
v_mfma_f32_16x16x32_bf16 v[12:15], v[116:119], v[60:63], v[12:15]
v_mfma_f32_16x16x32_bf16 v[4:7], v[116:119], v[128:131], v[4:7]
ds_read_b128 v[60:63], v41 offset:4896
v_mfma_f32_16x16x32_bf16 v[4:7], v[120:123], v[140:143], v[4:7]
ds_read_b128 v[88:91], v41 offset:4320
v_mfma_f32_16x16x32_bf16 v[4:7], v[104:107], v[68:71], v[4:7]
v_mfma_f32_16x16x32_bf16 v[4:7], v[100:103], v[80:83], v[4:7]
s_waitcnt lgkmcnt(2)
v_mfma_f32_16x16x32_bf16 v[4:7], v[132:135], v[64:67], v[4:7]
ds_read_b128 v[92:95], v41 offset:3744
v_mfma_f32_16x16x32_bf16 v[32:35], v[132:135], v[72:75], v[32:35]
ds_read_b64_tr_b16 v[96:97], v45 offset:2048
v_mfma_f32_16x16x32_bf16 v[32:35], v[100:103], v[84:87], v[32:35]
ds_read_b64_tr_b16 v[98:99], v45 offset:2304
v_mfma_f32_16x16x32_bf16 v[32:35], v[104:107], v[112:115], v[32:35]
s_barrier
ds_read_b64_tr_b16 v[124:125], v45 offset:4096
v_mfma_f32_16x16x32_bf16 v[32:35], v[120:123], v[108:111], v[32:35]
ds_read_b64_tr_b16 v[126:127], v45 offset:4352
v_mfma_f32_16x16x32_bf16 v[32:35], v[116:119], v[76:79], v[32:35]
ds_read_b64_tr_b16 v[76:77], v45 offset:6144
v_mfma_f32_16x16x32_bf16 v[24:27], v[116:119], v[108:111], v[24:27]
ds_read_b64_tr_b16 v[78:79], v45 offset:6400
v_mfma_f32_16x16x32_bf16 v[24:27], v[120:123], v[112:115], v[24:27]
ds_read_b64_tr_b16 v[108:109], v45 offset:8192
v_mfma_f32_16x16x32_bf16 v[24:27], v[104:107], v[84:87], v[24:27]
ds_read_b64_tr_b16 v[110:111], v45 offset:8448
v_mfma_f32_16x16x32_bf16 v[24:27], v[100:103], v[72:75], v[24:27]
ds_read_b128 v[128:131], v41 offset:2880
s_waitcnt lgkmcnt(7)
v_mfma_f32_16x16x32_bf16 v[24:27], v[132:135], v[60:63], v[24:27]
ds_read_b64_tr_b16 v[136:137], v45 offset:10240
v_mfma_f32_16x16x32_bf16 v[16:19], v[132:135], v[88:91], v[16:19]
ds_read_b64_tr_b16 v[138:139], v45 offset:10496
v_mfma_f32_16x16x32_bf16 v[16:19], v[100:103], v[60:63], v[16:19]
ds_read_b128 v[144:147], v41 offset:2304
v_mfma_f32_16x16x32_bf16 v[16:19], v[104:107], v[72:75], v[16:19]
v_mfma_f32_16x16x32_bf16 v[16:19], v[120:123], v[84:87], v[16:19]
v_mfma_f32_16x16x32_bf16 v[16:19], v[116:119], v[112:115], v[16:19]
v_mfma_f32_16x16x32_bf16 v[8:11], v[116:119], v[84:87], v[8:11]
v_mfma_f32_16x16x32_bf16 v[8:11], v[120:123], v[72:75], v[8:11]
v_mfma_f32_16x16x32_bf16 v[8:11], v[104:107], v[60:63], v[8:11]
v_mfma_f32_16x16x32_bf16 v[8:11], v[100:103], v[88:91], v[8:11]
v_mfma_f32_16x16x32_bf16 v[8:11], v[132:135], v[92:95], v[8:11]
v_mfma_f32_16x16x32_bf16 v[36:39], v[96:99], v[140:143], v[36:39]
ds_read_b128 v[72:75], v41 offset:1728
s_waitcnt lgkmcnt(1)
v_mfma_f32_16x16x32_bf16 v[36:39], v[124:127], v[68:71], v[36:39]
ds_read_b128 v[84:87], v41 offset:1152
v_mfma_f32_16x16x32_bf16 v[36:39], v[76:79], v[80:83], v[36:39]
v_mfma_f32_16x16x32_bf16 v[36:39], v[108:111], v[64:67], v[36:39]
v_mfma_f32_16x16x32_bf16 v[36:39], v[136:139], v[128:131], v[36:39]
v_mfma_f32_16x16x32_bf16 v[28:31], v[136:139], v[144:147], v[28:31]
v_mfma_f32_16x16x32_bf16 v[28:31], v[108:111], v[128:131], v[28:31]
v_mfma_f32_16x16x32_bf16 v[28:31], v[76:79], v[64:67], v[28:31]
v_mfma_f32_16x16x32_bf16 v[28:31], v[124:127], v[80:83], v[28:31]
v_mfma_f32_16x16x32_bf16 v[28:31], v[96:99], v[68:71], v[28:31]
v_mfma_f32_16x16x32_bf16 v[20:23], v[96:99], v[80:83], v[20:23]
ds_read_b128 v[68:71], v41 offset:576
v_mfma_f32_16x16x32_bf16 v[20:23], v[124:127], v[64:67], v[20:23]
ds_read_b128 v[80:83], v41 offset:2592
v_mfma_f32_16x16x32_bf16 v[20:23], v[76:79], v[128:131], v[20:23]
ds_read_b128 v[100:103], v41 offset:3168
v_mfma_f32_16x16x32_bf16 v[20:23], v[108:111], v[144:147], v[20:23]
s_waitcnt lgkmcnt(3)
v_mfma_f32_16x16x32_bf16 v[20:23], v[136:139], v[72:75], v[20:23]
v_mfma_f32_16x16x32_bf16 v[12:15], v[136:139], v[84:87], v[12:15]
v_mfma_f32_16x16x32_bf16 v[12:15], v[108:111], v[72:75], v[12:15]
v_mfma_f32_16x16x32_bf16 v[12:15], v[76:79], v[144:147], v[12:15]
v_mfma_f32_16x16x32_bf16 v[12:15], v[124:127], v[128:131], v[12:15]
ds_read_b128 v[104:107], v41 offset:2016
v_mfma_f32_16x16x32_bf16 v[12:15], v[96:99], v[64:67], v[12:15]
ds_read_b128 v[64:67], v41 offset:1440
v_mfma_f32_16x16x32_bf16 v[4:7], v[96:99], v[128:131], v[4:7]
ds_read_b128 v[112:115], v41 offset:864
v_mfma_f32_16x16x32_bf16 v[4:7], v[124:127], v[144:147], v[4:7]
ds_read_b128 v[116:119], v42 offset:10944
v_mfma_f32_16x16x32_bf16 v[4:7], v[76:79], v[72:75], v[4:7]
ds_read_b64_tr_b16 v[72:73], v45 offset:12288
v_mfma_f32_16x16x32_bf16 v[4:7], v[108:111], v[84:87], v[4:7]
ds_read_b64_tr_b16 v[74:75], v45 offset:12544
s_waitcnt lgkmcnt(6)
v_mfma_f32_16x16x32_bf16 v[4:7], v[136:139], v[68:71], v[4:7]
ds_read_b128 v[68:71], v42 offset:10368
v_mfma_f32_16x16x32_bf16 v[32:35], v[136:139], v[80:83], v[32:35]
ds_read_b64_tr_b16 v[84:85], v45 offset:14336
v_mfma_f32_16x16x32_bf16 v[32:35], v[108:111], v[100:103], v[32:35]
ds_read_b64_tr_b16 v[86:87], v45 offset:14592
v_mfma_f32_16x16x32_bf16 v[32:35], v[76:79], v[92:95], v[32:35]
ds_read_b128 v[120:123], v42 offset:9792
v_mfma_f32_16x16x32_bf16 v[32:35], v[124:127], v[88:91], v[32:35]
ds_read_b64_tr_b16 v[128:129], v45 offset:16384
v_mfma_f32_16x16x32_bf16 v[32:35], v[96:99], v[60:63], v[32:35]
ds_read_b64_tr_b16 v[130:131], v45 offset:16640
v_mfma_f32_16x16x32_bf16 v[24:27], v[96:99], v[88:91], v[24:27]
ds_read_b128 v[60:63], v42 offset:9216
v_mfma_f32_16x16x32_bf16 v[24:27], v[124:127], v[92:95], v[24:27]
ds_read_b64_tr_b16 v[88:89], v45 offset:18432
v_mfma_f32_16x16x32_bf16 v[24:27], v[76:79], v[100:103], v[24:27]
ds_read_b64_tr_b16 v[90:91], v45 offset:18688
v_mfma_f32_16x16x32_bf16 v[24:27], v[108:111], v[80:83], v[24:27]
ds_read_b128 v[132:135], v42 offset:8640
s_waitcnt lgkmcnt(7)
v_mfma_f32_16x16x32_bf16 v[24:27], v[136:139], v[104:107], v[24:27]
ds_read_b64_tr_b16 v[140:141], v45 offset:20480
v_mfma_f32_16x16x32_bf16 v[16:19], v[136:139], v[64:67], v[16:19]
ds_read_b64_tr_b16 v[142:143], v45 offset:20736
v_mfma_f32_16x16x32_bf16 v[16:19], v[108:111], v[104:107], v[16:19]
ds_read_b128 v[144:147], v42 offset:8064
v_mfma_f32_16x16x32_bf16 v[16:19], v[76:79], v[80:83], v[16:19]
v_mfma_f32_16x16x32_bf16 v[16:19], v[124:127], v[100:103], v[16:19]
v_mfma_f32_16x16x32_bf16 v[16:19], v[96:99], v[92:95], v[16:19]
v_mfma_f32_16x16x32_bf16 v[8:11], v[96:99], v[100:103], v[8:11]
v_mfma_f32_16x16x32_bf16 v[8:11], v[124:127], v[80:83], v[8:11]
v_mfma_f32_16x16x32_bf16 v[8:11], v[76:79], v[104:107], v[8:11]
v_mfma_f32_16x16x32_bf16 v[8:11], v[108:111], v[64:67], v[8:11]
v_mfma_f32_16x16x32_bf16 v[8:11], v[136:139], v[112:115], v[8:11]
v_mfma_f32_16x16x32_bf16 v[36:39], v[72:75], v[116:119], v[36:39]
ds_read_b128 v[64:67], v42 offset:7488
v_mfma_f32_16x16x32_bf16 v[36:39], v[84:87], v[68:71], v[36:39]
ds_read_b128 v[76:79], v42 offset:6912
s_waitcnt lgkmcnt(2)
v_mfma_f32_16x16x32_bf16 v[36:39], v[128:131], v[120:123], v[36:39]
v_mfma_f32_16x16x32_bf16 v[36:39], v[88:91], v[60:63], v[36:39]
v_mfma_f32_16x16x32_bf16 v[36:39], v[140:143], v[132:135], v[36:39]
v_mfma_f32_16x16x32_bf16 v[28:31], v[140:143], v[144:147], v[28:31]
v_mfma_f32_16x16x32_bf16 v[28:31], v[88:91], v[132:135], v[28:31]
v_mfma_f32_16x16x32_bf16 v[28:31], v[128:131], v[60:63], v[28:31]
v_mfma_f32_16x16x32_bf16 v[28:31], v[84:87], v[120:123], v[28:31]
v_mfma_f32_16x16x32_bf16 v[28:31], v[72:75], v[68:71], v[28:31]
v_mfma_f32_16x16x32_bf16 v[20:23], v[72:75], v[120:123], v[20:23]
ds_read_b128 v[68:71], v42 offset:6336
v_mfma_f32_16x16x32_bf16 v[20:23], v[84:87], v[60:63], v[20:23]
ds_read_b128 v[80:83], v42 offset:8352
v_mfma_f32_16x16x32_bf16 v[20:23], v[128:131], v[132:135], v[20:23]
ds_read_b128 v[92:95], v42 offset:8928
v_mfma_f32_16x16x32_bf16 v[20:23], v[88:91], v[144:147], v[20:23]
ds_read_b128 v[96:99], v42 offset:9504
s_waitcnt lgkmcnt(4)
v_mfma_f32_16x16x32_bf16 v[20:23], v[140:143], v[64:67], v[20:23]
ds_read_b128 v[100:103], v42 offset:10080
v_mfma_f32_16x16x32_bf16 v[12:15], v[140:143], v[76:79], v[12:15]
ds_read_b128 v[104:107], v42 offset:10656
v_mfma_f32_16x16x32_bf16 v[12:15], v[88:91], v[64:67], v[12:15]
v_mfma_f32_16x16x32_bf16 v[12:15], v[128:131], v[144:147], v[12:15]
v_mfma_f32_16x16x32_bf16 v[12:15], v[84:87], v[132:135], v[12:15]
v_mfma_f32_16x16x32_bf16 v[12:15], v[72:75], v[60:63], v[12:15]
v_mfma_f32_16x16x32_bf16 v[4:7], v[72:75], v[132:135], v[4:7]
ds_read_b128 v[60:63], v42 offset:7776
v_mfma_f32_16x16x32_bf16 v[4:7], v[84:87], v[144:147], v[4:7]
ds_read_b128 v[108:111], v42 offset:7200
v_mfma_f32_16x16x32_bf16 v[4:7], v[128:131], v[64:67], v[4:7]
v_mfma_f32_16x16x32_bf16 v[4:7], v[88:91], v[76:79], v[4:7]
s_waitcnt lgkmcnt(2)
v_mfma_f32_16x16x32_bf16 v[4:7], v[140:143], v[68:71], v[4:7]
ds_read_b128 v[112:115], v42 offset:6624
v_mfma_f32_16x16x32_bf16 v[32:35], v[140:143], v[80:83], v[32:35]
ds_read_b64_tr_b16 v[116:117], v45 offset:22528
v_mfma_f32_16x16x32_bf16 v[32:35], v[88:91], v[92:95], v[32:35]
ds_read_b64_tr_b16 v[118:119], v45 offset:22784
v_mfma_f32_16x16x32_bf16 v[32:35], v[128:131], v[96:99], v[32:35]
s_barrier
ds_read_b64_tr_b16 v[120:121], v45 offset:24576
v_mfma_f32_16x16x32_bf16 v[32:35], v[84:87], v[100:103], v[32:35]
ds_read_b64_tr_b16 v[122:123], v45 offset:24832
v_mfma_f32_16x16x32_bf16 v[32:35], v[72:75], v[104:107], v[32:35]
ds_read_b64_tr_b16 v[104:105], v45 offset:26624
v_mfma_f32_16x16x32_bf16 v[24:27], v[72:75], v[100:103], v[24:27]
ds_read_b64_tr_b16 v[106:107], v45 offset:26880
v_mfma_f32_16x16x32_bf16 v[24:27], v[84:87], v[96:99], v[24:27]
ds_read_b64_tr_b16 v[100:101], v45 offset:28672
v_mfma_f32_16x16x32_bf16 v[24:27], v[128:131], v[92:95], v[24:27]
ds_read_b64_tr_b16 v[102:103], v45 offset:28928
v_mfma_f32_16x16x32_bf16 v[24:27], v[88:91], v[80:83], v[24:27]
ds_read_b128 v[124:127], v42 offset:5760
s_waitcnt lgkmcnt(7)
v_mfma_f32_16x16x32_bf16 v[24:27], v[140:143], v[60:63], v[24:27]
ds_read_b64_tr_b16 v[132:133], v45 offset:30720
v_mfma_f32_16x16x32_bf16 v[16:19], v[140:143], v[108:111], v[16:19]
ds_read_b64_tr_b16 v[134:135], v45 offset:30976
v_mfma_f32_16x16x32_bf16 v[16:19], v[88:91], v[60:63], v[16:19]
ds_read_b128 v[136:139], v42 offset:5184
v_mfma_f32_16x16x32_bf16 v[16:19], v[128:131], v[80:83], v[16:19]
v_mfma_f32_16x16x32_bf16 v[16:19], v[84:87], v[92:95], v[16:19]
v_mfma_f32_16x16x32_bf16 v[16:19], v[72:75], v[96:99], v[16:19]
v_mfma_f32_16x16x32_bf16 v[8:11], v[72:75], v[92:95], v[8:11]
v_mfma_f32_16x16x32_bf16 v[8:11], v[84:87], v[80:83], v[8:11]
v_mfma_f32_16x16x32_bf16 v[8:11], v[128:131], v[60:63], v[8:11]
v_mfma_f32_16x16x32_bf16 v[8:11], v[88:91], v[108:111], v[8:11]
v_mfma_f32_16x16x32_bf16 v[8:11], v[140:143], v[112:115], v[8:11]
v_mfma_f32_16x16x32_bf16 v[36:39], v[116:119], v[144:147], v[36:39]
ds_read_b128 v[72:75], v42 offset:4608
s_waitcnt lgkmcnt(1)
v_mfma_f32_16x16x32_bf16 v[36:39], v[120:123], v[64:67], v[36:39]
ds_read_b128 v[80:83], v42 offset:4032
v_mfma_f32_16x16x32_bf16 v[36:39], v[104:107], v[76:79], v[36:39]
v_mfma_f32_16x16x32_bf16 v[36:39], v[100:103], v[68:71], v[36:39]
v_mfma_f32_16x16x32_bf16 v[36:39], v[132:135], v[124:127], v[36:39]
v_mfma_f32_16x16x32_bf16 v[28:31], v[132:135], v[136:139], v[28:31]
v_mfma_f32_16x16x32_bf16 v[28:31], v[100:103], v[124:127], v[28:31]
v_mfma_f32_16x16x32_bf16 v[28:31], v[104:107], v[68:71], v[28:31]
v_mfma_f32_16x16x32_bf16 v[28:31], v[120:123], v[76:79], v[28:31]
v_mfma_f32_16x16x32_bf16 v[28:31], v[116:119], v[64:67], v[28:31]
v_mfma_f32_16x16x32_bf16 v[20:23], v[116:119], v[76:79], v[20:23]
ds_read_b128 v[64:67], v42 offset:3456
v_mfma_f32_16x16x32_bf16 v[20:23], v[120:123], v[68:71], v[20:23]
ds_read_b128 v[76:79], v42 offset:5472
v_mfma_f32_16x16x32_bf16 v[20:23], v[104:107], v[124:127], v[20:23]
ds_read_b128 v[84:87], v42 offset:6048
v_mfma_f32_16x16x32_bf16 v[20:23], v[100:103], v[136:139], v[20:23]
s_waitcnt lgkmcnt(3)
v_mfma_f32_16x16x32_bf16 v[20:23], v[132:135], v[72:75], v[20:23]
v_mfma_f32_16x16x32_bf16 v[12:15], v[132:135], v[80:83], v[12:15]
v_mfma_f32_16x16x32_bf16 v[12:15], v[100:103], v[72:75], v[12:15]
v_mfma_f32_16x16x32_bf16 v[12:15], v[104:107], v[136:139], v[12:15]
v_mfma_f32_16x16x32_bf16 v[12:15], v[120:123], v[124:127], v[12:15]
v_mfma_f32_16x16x32_bf16 v[12:15], v[116:119], v[68:71], v[12:15]
ds_read_b128 v[68:71], v42 offset:4896
v_mfma_f32_16x16x32_bf16 v[4:7], v[116:119], v[124:127], v[4:7]
ds_read_b128 v[88:91], v42 offset:4320
v_mfma_f32_16x16x32_bf16 v[4:7], v[120:123], v[136:139], v[4:7]
ds_read_b128 v[92:95], v42 offset:3744
v_mfma_f32_16x16x32_bf16 v[4:7], v[104:107], v[72:75], v[4:7]
ds_read_b64_tr_b16 v[96:97], v45 offset:32768
v_mfma_f32_16x16x32_bf16 v[4:7], v[100:103], v[80:83], v[4:7]
ds_read_b64_tr_b16 v[98:99], v45 offset:33024
s_waitcnt lgkmcnt(5)
v_mfma_f32_16x16x32_bf16 v[4:7], v[132:135], v[64:67], v[4:7]
ds_read_b64_tr_b16 v[124:125], v45 offset:34816
v_mfma_f32_16x16x32_bf16 v[32:35], v[132:135], v[76:79], v[32:35]
ds_read_b64_tr_b16 v[126:127], v45 offset:35072
v_mfma_f32_16x16x32_bf16 v[32:35], v[100:103], v[84:87], v[32:35]
ds_read_b64_tr_b16 v[128:129], v45 offset:36864
v_mfma_f32_16x16x32_bf16 v[32:35], v[104:107], v[112:115], v[32:35]
ds_read_b64_tr_b16 v[130:131], v45 offset:37120
v_mfma_f32_16x16x32_bf16 v[32:35], v[120:123], v[108:111], v[32:35]
ds_read_b64_tr_b16 v[140:141], v45 offset:38912
v_mfma_f32_16x16x32_bf16 v[32:35], v[116:119], v[60:63], v[32:35]
ds_read_b64_tr_b16 v[142:143], v45 offset:39168
v_mfma_f32_16x16x32_bf16 v[24:27], v[116:119], v[108:111], v[24:27]
ds_read_b128 v[60:63], v42 offset:2880
v_mfma_f32_16x16x32_bf16 v[24:27], v[120:123], v[112:115], v[24:27]
ds_read_b64_tr_b16 v[108:109], v45 offset:40960
v_mfma_f32_16x16x32_bf16 v[24:27], v[104:107], v[84:87], v[24:27]
ds_read_b64_tr_b16 v[110:111], v45 offset:41216
v_mfma_f32_16x16x32_bf16 v[24:27], v[100:103], v[76:79], v[24:27]
ds_read_b128 v[144:147], v42 offset:2304
s_waitcnt lgkmcnt(7)
v_mfma_f32_16x16x32_bf16 v[24:27], v[132:135], v[68:71], v[24:27]
ds_read_b128 v[148:151], v42 offset:1728
v_mfma_f32_16x16x32_bf16 v[16:19], v[132:135], v[88:91], v[16:19]
ds_read_b128 v[152:155], v42 offset:1152
v_mfma_f32_16x16x32_bf16 v[16:19], v[100:103], v[68:71], v[16:19]
ds_read_b128 v[156:159], v42 offset:576
v_mfma_f32_16x16x32_bf16 v[16:19], v[104:107], v[76:79], v[16:19]
v_mfma_f32_16x16x32_bf16 v[16:19], v[120:123], v[84:87], v[16:19]
ds_read_b128 v[160:163], v42 offset:2592
v_mfma_f32_16x16x32_bf16 v[16:19], v[116:119], v[112:115], v[16:19]
ds_read_b128 v[112:115], v42 offset:3168
v_mfma_f32_16x16x32_bf16 v[8:11], v[116:119], v[84:87], v[8:11]
v_mfma_f32_16x16x32_bf16 v[8:11], v[120:123], v[76:79], v[8:11]
ds_read_b128 v[76:79], v42 offset:2016
v_mfma_f32_16x16x32_bf16 v[8:11], v[104:107], v[68:71], v[8:11]
ds_read_b128 v[84:87], v42 offset:1440
v_mfma_f32_16x16x32_bf16 v[8:11], v[100:103], v[88:91], v[8:11]
ds_read_b128 v[100:103], v42 offset:864
v_mfma_f32_16x16x32_bf16 v[8:11], v[132:135], v[92:95], v[8:11]
ds_read_b128 v[104:107], v43 offset:10944
v_mfma_f32_16x16x32_bf16 v[36:39], v[96:99], v[136:139], v[36:39]
ds_read_b64_tr_b16 v[116:117], v45 offset:43008
v_mfma_f32_16x16x32_bf16 v[36:39], v[124:127], v[72:75], v[36:39]
ds_read_b64_tr_b16 v[118:119], v45 offset:43264
s_waitcnt lgkmcnt(6)
v_mfma_f32_16x16x32_bf16 v[36:39], v[128:131], v[80:83], v[36:39]
ds_read_b128 v[120:123], v43 offset:10368
v_mfma_f32_16x16x32_bf16 v[36:39], v[140:143], v[64:67], v[36:39]
s_barrier
ds_read_b64_tr_b16 v[132:133], v45 offset:45056
v_mfma_f32_16x16x32_bf16 v[36:39], v[108:111], v[60:63], v[36:39]
ds_read_b64_tr_b16 v[134:135], v45 offset:45312
v_mfma_f32_16x16x32_bf16 v[28:31], v[108:111], v[144:147], v[28:31]
ds_read_b128 v[136:139], v43 offset:9792
v_mfma_f32_16x16x32_bf16 v[28:31], v[140:143], v[60:63], v[28:31]
ds_read_b64_tr_b16 v[164:165], v45 offset:47104
v_mfma_f32_16x16x32_bf16 v[28:31], v[128:131], v[64:67], v[28:31]
ds_read_b64_tr_b16 v[166:167], v45 offset:47360
v_mfma_f32_16x16x32_bf16 v[28:31], v[124:127], v[80:83], v[28:31]
ds_read_b128 v[168:171], v43 offset:9216
v_mfma_f32_16x16x32_bf16 v[28:31], v[96:99], v[72:75], v[28:31]
ds_read_b64_tr_b16 v[72:73], v45 offset:49152
v_mfma_f32_16x16x32_bf16 v[20:23], v[96:99], v[80:83], v[20:23]
ds_read_b64_tr_b16 v[74:75], v45 offset:49408
v_mfma_f32_16x16x32_bf16 v[20:23], v[124:127], v[64:67], v[20:23]
ds_read_b128 v[80:83], v43 offset:8640
v_mfma_f32_16x16x32_bf16 v[20:23], v[128:131], v[60:63], v[20:23]
ds_read_b64_tr_b16 v[172:173], v45 offset:51200
v_mfma_f32_16x16x32_bf16 v[20:23], v[140:143], v[144:147], v[20:23]
ds_read_b64_tr_b16 v[174:175], v45 offset:51456
v_mfma_f32_16x16x32_bf16 v[20:23], v[108:111], v[148:151], v[20:23]
ds_read_b128 v[176:179], v43 offset:8064
v_mfma_f32_16x16x32_bf16 v[12:15], v[108:111], v[152:155], v[12:15]
ds_read_b64_tr_b16 v[180:181], v45 offset:53248
v_mfma_f32_16x16x32_bf16 v[12:15], v[140:143], v[148:151], v[12:15]
ds_read_b64_tr_b16 v[182:183], v45 offset:53504
v_mfma_f32_16x16x32_bf16 v[12:15], v[128:131], v[144:147], v[12:15]
ds_read_b128 v[184:187], v43 offset:7488
v_mfma_f32_16x16x32_bf16 v[12:15], v[124:127], v[60:63], v[12:15]
ds_read_b64_tr_b16 v[188:189], v45 offset:55296
v_mfma_f32_16x16x32_bf16 v[12:15], v[96:99], v[64:67], v[12:15]
ds_read_b64_tr_b16 v[190:191], v45 offset:55552
v_mfma_f32_16x16x32_bf16 v[4:7], v[96:99], v[60:63], v[4:7]
ds_read_b128 v[60:63], v43 offset:6912
v_mfma_f32_16x16x32_bf16 v[4:7], v[124:127], v[144:147], v[4:7]
ds_read_b64_tr_b16 v[64:65], v45 offset:57344
v_mfma_f32_16x16x32_bf16 v[4:7], v[128:131], v[148:151], v[4:7]
ds_read_b64_tr_b16 v[66:67], v45 offset:57600
v_mfma_f32_16x16x32_bf16 v[4:7], v[140:143], v[152:155], v[4:7]
ds_read_b128 v[144:147], v43 offset:6336
v_mfma_f32_16x16x32_bf16 v[4:7], v[108:111], v[156:159], v[4:7]
ds_read_b64_tr_b16 v[148:149], v45 offset:59392
v_mfma_f32_16x16x32_bf16 v[32:35], v[108:111], v[160:163], v[32:35]
ds_read_b64_tr_b16 v[150:151], v45 offset:59648
v_mfma_f32_16x16x32_bf16 v[32:35], v[140:143], v[112:115], v[32:35]
ds_read_b128 v[152:155], v43 offset:5760
v_mfma_f32_16x16x32_bf16 v[32:35], v[128:131], v[92:95], v[32:35]
ds_read_b64_tr_b16 v[156:157], v45 offset:61440
v_mfma_f32_16x16x32_bf16 v[32:35], v[124:127], v[88:91], v[32:35]
ds_read_b64_tr_b16 v[158:159], v45 offset:61696
v_mfma_f32_16x16x32_bf16 v[32:35], v[96:99], v[68:71], v[32:35]
ds_read_b128 v[68:71], v43 offset:5184
v_mfma_f32_16x16x32_bf16 v[24:27], v[96:99], v[88:91], v[24:27]
ds_read_b64_tr_b16 v[88:89], v45 offset:63488
v_mfma_f32_16x16x32_bf16 v[24:27], v[124:127], v[92:95], v[24:27]
ds_read_b64_tr_b16 v[90:91], v45 offset:63744
v_mfma_f32_16x16x32_bf16 v[24:27], v[128:131], v[112:115], v[24:27]
ds_read_b128 v[192:195], v43 offset:4608
v_mfma_f32_16x16x32_bf16 v[24:27], v[140:143], v[160:163], v[24:27]
ds_read_b64_tr_b16 v[196:197], v45 offset:0
s_waitcnt lgkmcnt(7)
v_mfma_f32_16x16x32_bf16 v[24:27], v[108:111], v[76:79], v[24:27]
ds_read_b64_tr_b16 v[198:199], v45 offset:256
v_mfma_f32_16x16x32_bf16 v[16:19], v[108:111], v[84:87], v[16:19]
ds_read_b128 v[200:203], v43 offset:4032
v_mfma_f32_16x16x32_bf16 v[16:19], v[140:143], v[76:79], v[16:19]
ds_read_b64_tr_b16 v[204:205], v45 offset:2048
v_mfma_f32_16x16x32_bf16 v[16:19], v[128:131], v[160:163], v[16:19]
ds_read_b64_tr_b16 v[206:207], v45 offset:2304
v_mfma_f32_16x16x32_bf16 v[16:19], v[124:127], v[112:115], v[16:19]
ds_read_b128 v[208:211], v43 offset:3456
v_mfma_f32_16x16x32_bf16 v[16:19], v[96:99], v[92:95], v[16:19]
ds_read_b64_tr_b16 v[92:93], v45 offset:4096
v_mfma_f32_16x16x32_bf16 v[8:11], v[96:99], v[112:115], v[8:11]
L_ct1:
s_cbranch_scc1 L_cr1
ds_read_b64_tr_b16 v[94:95], v45 offset:4352
v_mfma_f32_16x16x32_bf16 v[8:11], v[124:127], v[160:163], v[8:11]
ds_read_b128 v[96:99], v43 offset:2880
v_mfma_f32_16x16x32_bf16 v[8:11], v[128:131], v[76:79], v[8:11]
ds_read_b64_tr_b16 v[76:77], v45 offset:6144
v_mfma_f32_16x16x32_bf16 v[8:11], v[140:143], v[84:87], v[8:11]
ds_read_b64_tr_b16 v[78:79], v45 offset:6400
v_mfma_f32_16x16x32_bf16 v[8:11], v[108:111], v[100:103], v[8:11]
ds_read_b128 v[84:87], v43 offset:2304
v_mfma_f32_16x16x32_bf16 v[36:39], v[116:119], v[104:107], v[36:39]
v_mfma_f32_16x16x32_bf16 v[36:39], v[132:135], v[120:123], v[36:39]
v_mfma_f32_16x16x32_bf16 v[36:39], v[164:167], v[136:139], v[36:39]
ds_read_b128 v[100:103], v43 offset:1728
v_mfma_f32_16x16x32_bf16 v[36:39], v[72:75], v[168:171], v[36:39]
ds_read_b128 v[104:107], v43 offset:1152
v_mfma_f32_16x16x32_bf16 v[36:39], v[172:175], v[80:83], v[36:39]
ds_read_b128 v[108:111], v43 offset:576
v_mfma_f32_16x16x32_bf16 v[36:39], v[180:183], v[176:179], v[36:39]
ds_read_b128 v[112:115], v43 offset:10656
v_mfma_f32_16x16x32_bf16 v[36:39], v[188:191], v[184:187], v[36:39]
ds_read_b128 v[124:127], v43 offset:10080
v_mfma_f32_16x16x32_bf16 v[36:39], v[64:67], v[60:63], v[36:39]
ds_read_b128 v[128:131], v43 offset:9504
v_mfma_f32_16x16x32_bf16 v[36:39], v[148:151], v[144:147], v[36:39]
ds_read_b128 v[140:143], v43 offset:8928
s_waitcnt lgkmcnt(7)
v_mfma_f32_16x16x32_bf16 v[36:39], v[156:159], v[152:155], v[36:39]
s_waitcnt vmcnt(0)
s_barrier
v_mfma_f32_16x16x32_bf16 v[36:39], v[88:91], v[68:71], v[36:39]
v_mfma_f32_16x16x32_bf16 v[36:39], v[196:199], v[192:195], v[36:39]
ds_read_b128 v[160:163], v43 offset:8352
v_mfma_f32_16x16x32_bf16 v[36:39], v[204:207], v[200:203], v[36:39]
ds_read_b128 v[212:215], v43 offset:7776
v_mfma_f32_16x16x32_bf16 v[36:39], v[92:95], v[208:211], v[36:39]
ds_read_b128 v[216:219], v43 offset:7200
v_mfma_f32_16x16x32_bf16 v[36:39], v[76:79], v[96:99], v[36:39]
ds_read_b128 v[220:223], v43 offset:6624
v_mfma_f32_16x16x32_bf16 v[28:31], v[116:119], v[120:123], v[28:31]
ds_read_b128 v[120:123], v43 offset:6048
v_mfma_f32_16x16x32_bf16 v[28:31], v[132:135], v[136:139], v[28:31]
ds_read_b128 v[224:227], v43 offset:5472
v_mfma_f32_16x16x32_bf16 v[28:31], v[164:167], v[168:171], v[28:31]
ds_read_b128 v[228:231], v43 offset:4896
v_mfma_f32_16x16x32_bf16 v[28:31], v[72:75], v[80:83], v[28:31]
v_mul_f32 v48, s56, v36
v_mul_f32 v49, s56, v37
v_mfma_f32_16x16x32_bf16 v[28:31], v[172:175], v[176:179], v[28:31]
v_mul_f32 v50, s56, v38
v_mul_f32 v51, s56, v39
v_mfma_f32_16x16x32_bf16 v[28:31], v[180:183], v[184:187], v[28:31]
v_exp_f32 v48, v48
v_mfma_f32_16x16x32_bf16 v[28:31], v[188:191], v[60:63], v[28:31]
v_exp_f32 v49, v49
v_mfma_f32_16x16x32_bf16 v[28:31], v[64:67], v[144:147], v[28:31]
v_exp_f32 v50, v50
v_mfma_f32_16x16x32_bf16 v[28:31], v[148:151], v[152:155], v[28:31]
v_exp_f32 v51, v51
v_mfma_f32_16x16x32_bf16 v[28:31], v[156:159], v[68:71], v[28:31]
v_add_f32 v48, s57, v48
v_add_f32 v49, s57, v49
v_mfma_f32_16x16x32_bf16 v[28:31], v[88:91], v[192:195], v[28:31]
v_add_f32 v50, s57, v50
v_add_f32 v51, s57, v51
v_mfma_f32_16x16x32_bf16 v[28:31], v[196:199], v[200:203], v[28:31]
v_rcp_f32 v48, v48
v_mfma_f32_16x16x32_bf16 v[28:31], v[204:207], v[208:211], v[28:31]
v_rcp_f32 v49, v49
v_mfma_f32_16x16x32_bf16 v[28:31], v[92:95], v[96:99], v[28:31]
v_rcp_f32 v50, v50
v_mfma_f32_16x16x32_bf16 v[28:31], v[76:79], v[84:87], v[28:31]
v_rcp_f32 v51, v51
v_mfma_f32_16x16x32_bf16 v[20:23], v[116:119], v[136:139], v[20:23]
ds_read_b128 v[136:139], v43 offset:4320
v_add_f32 v48, v46, v48
v_add_f32 v49, v46, v49
v_mfma_f32_16x16x32_bf16 v[20:23], v[132:135], v[168:171], v[20:23]
v_add_f32 v50, v46, v50
v_add_f32 v51, v46, v51
v_mfma_f32_16x16x32_bf16 v[20:23], v[164:167], v[80:83], v[20:23]
v_cvt_pk_bf16_f32 v56, v48, v49
v_cvt_pk_bf16_f32 v57, v50, v51
v_mfma_f32_16x16x32_bf16 v[20:23], v[72:75], v[176:179], v[20:23]
buffer_store_dwordx2 v[56:57], v47, s[32:35], s72 offen sc1
v_mul_f32 v52, s56, v28
v_mul_f32 v53, s56, v29
v_mfma_f32_16x16x32_bf16 v[20:23], v[172:175], v[184:187], v[20:23]
v_mul_f32 v54, s56, v30
v_mul_f32 v55, s56, v31
v_mfma_f32_16x16x32_bf16 v[20:23], v[180:183], v[60:63], v[20:23]
v_exp_f32 v52, v52
v_mfma_f32_16x16x32_bf16 v[20:23], v[188:191], v[144:147], v[20:23]
v_exp_f32 v53, v53
v_mfma_f32_16x16x32_bf16 v[20:23], v[64:67], v[152:155], v[20:23]
v_exp_f32 v54, v54
v_mfma_f32_16x16x32_bf16 v[20:23], v[148:151], v[68:71], v[20:23]
v_exp_f32 v55, v55
v_mfma_f32_16x16x32_bf16 v[20:23], v[156:159], v[192:195], v[20:23]
v_add_f32 v52, s57, v52
v_add_f32 v53, s57, v53
v_mfma_f32_16x16x32_bf16 v[20:23], v[88:91], v[200:203], v[20:23]
v_add_f32 v54, s57, v54
v_add_f32 v55, s57, v55
v_mfma_f32_16x16x32_bf16 v[20:23], v[196:199], v[208:211], v[20:23]
v_rcp_f32 v52, v52
v_mfma_f32_16x16x32_bf16 v[20:23], v[204:207], v[96:99], v[20:23]
v_rcp_f32 v53, v53
v_mfma_f32_16x16x32_bf16 v[20:23], v[92:95], v[84:87], v[20:23]
v_rcp_f32 v54, v54
s_waitcnt lgkmcnt(0)
v_mfma_f32_16x16x32_bf16 v[20:23], v[76:79], v[100:103], v[20:23]
v_rcp_f32 v55, v55
v_mfma_f32_16x16x32_bf16 v[12:15], v[116:119], v[168:171], v[12:15]
ds_read_b128 v[168:171], v43 offset:3744
v_add_f32 v52, v46, v52
v_add_f32 v53, v46, v53
v_mfma_f32_16x16x32_bf16 v[12:15], v[132:135], v[80:83], v[12:15]
v_add_f32 v54, v46, v54
v_add_f32 v55, v46, v55
v_mfma_f32_16x16x32_bf16 v[12:15], v[164:167], v[176:179], v[12:15]
v_cvt_pk_bf16_f32 v58, v52, v53
v_cvt_pk_bf16_f32 v59, v54, v55
v_mfma_f32_16x16x32_bf16 v[12:15], v[72:75], v[184:187], v[12:15]
buffer_store_dwordx2 v[58:59], v47, s[32:35], s70 offen sc1
v_mul_f32 v48, s56, v20
v_mul_f32 v49, s56, v21
v_mfma_f32_16x16x32_bf16 v[12:15], v[172:175], v[60:63], v[12:15]
v_mul_f32 v50, s56, v22
v_mul_f32 v51, s56, v23
v_mfma_f32_16x16x32_bf16 v[12:15], v[180:183], v[144:147], v[12:15]
v_exp_f32 v48, v48
v_mfma_f32_16x16x32_bf16 v[12:15], v[188:191], v[152:155], v[12:15]
v_exp_f32 v49, v49
v_mfma_f32_16x16x32_bf16 v[12:15], v[64:67], v[68:71], v[12:15]
v_exp_f32 v50, v50
v_mfma_f32_16x16x32_bf16 v[12:15], v[148:151], v[192:195], v[12:15]
v_exp_f32 v51, v51
v_mfma_f32_16x16x32_bf16 v[12:15], v[156:159], v[200:203], v[12:15]
v_add_f32 v48, s57, v48
v_add_f32 v49, s57, v49
v_mfma_f32_16x16x32_bf16 v[12:15], v[88:91], v[208:211], v[12:15]
v_add_f32 v50, s57, v50
v_add_f32 v51, s57, v51
v_mfma_f32_16x16x32_bf16 v[12:15], v[196:199], v[96:99], v[12:15]
v_rcp_f32 v48, v48
v_mfma_f32_16x16x32_bf16 v[12:15], v[204:207], v[84:87], v[12:15]
v_rcp_f32 v49, v49
v_mfma_f32_16x16x32_bf16 v[12:15], v[92:95], v[100:103], v[12:15]
v_rcp_f32 v50, v50
v_mfma_f32_16x16x32_bf16 v[12:15], v[76:79], v[104:107], v[12:15]
v_rcp_f32 v51, v51
v_mfma_f32_16x16x32_bf16 v[4:7], v[116:119], v[80:83], v[4:7]
ds_read_b128 v[80:83], v43 offset:3168
v_add_f32 v48, v46, v48
v_add_f32 v49, v46, v49
v_mfma_f32_16x16x32_bf16 v[4:7], v[132:135], v[176:179], v[4:7]
v_add_f32 v50, v46, v50
v_add_f32 v51, v46, v51
v_mfma_f32_16x16x32_bf16 v[4:7], v[164:167], v[184:187], v[4:7]
v_cvt_pk_bf16_f32 v56, v48, v49
L_ct2:
s_cbranch_scc1 L_cr2
v_cvt_pk_bf16_f32 v57, v50, v51
v_mfma_f32_16x16x32_bf16 v[4:7], v[72:75], v[60:63], v[4:7]
buffer_store_dwordx2 v[56:57], v47, s[32:35], s68 offen sc1
v_mul_f32 v52, s56, v12
v_mul_f32 v53, s56, v13
v_mfma_f32_16x16x32_bf16 v[4:7], v[172:175], v[144:147], v[4:7]
v_mul_f32 v54, s56, v14
v_mul_f32 v55, s56, v15
v_mfma_f32_16x16x32_bf16 v[4:7], v[180:183], v[152:155], v[4:7]
v_exp_f32 v52, v52
v_mfma_f32_16x16x32_bf16 v[4:7], v[188:191], v[68:71], v[4:7]
v_exp_f32 v53, v53
v_mfma_f32_16x16x32_bf16 v[4:7], v[64:67], v[192:195], v[4:7]
v_exp_f32 v54, v54
v_mfma_f32_16x16x32_bf16 v[4:7], v[148:151], v[200:203], v[4:7]
v_exp_f32 v55, v55
v_mfma_f32_16x16x32_bf16 v[4:7], v[156:159], v[208:211], v[4:7]
v_add_f32 v52, s57, v52
v_add_f32 v53, s57, v53
v_mfma_f32_16x16x32_bf16 v[4:7], v[88:91], v[96:99], v[4:7]
v_add_f32 v54, s57, v54
v_add_f32 v55, s57, v55
v_mfma_f32_16x16x32_bf16 v[4:7], v[196:199], v[84:87], v[4:7]
v_rcp_f32 v52, v52
v_mfma_f32_16x16x32_bf16 v[4:7], v[204:207], v[100:103], v[4:7]
v_rcp_f32 v53, v53
v_mfma_f32_16x16x32_bf16 v[4:7], v[92:95], v[104:107], v[4:7]
v_rcp_f32 v54, v54
v_mfma_f32_16x16x32_bf16 v[4:7], v[76:79], v[108:111], v[4:7]
v_rcp_f32 v55, v55
v_mfma_f32_16x16x32_bf16 v[32:35], v[116:119], v[112:115], v[32:35]
ds_read_b128 v[60:63], v43 offset:2592
v_add_f32 v52, v46, v52
v_add_f32 v53, v46, v53
v_mfma_f32_16x16x32_bf16 v[32:35], v[132:135], v[124:127], v[32:35]
v_add_f32 v54, v46, v54
v_add_f32 v55, v46, v55
v_mfma_f32_16x16x32_bf16 v[32:35], v[164:167], v[128:131], v[32:35]
v_cvt_pk_bf16_f32 v58, v52, v53
v_cvt_pk_bf16_f32 v59, v54, v55
v_mfma_f32_16x16x32_bf16 v[32:35], v[72:75], v[140:143], v[32:35]
buffer_store_dwordx2 v[58:59], v47, s[32:35], s66 offen sc1
v_mul_f32 v48, s56, v4
v_mul_f32 v49, s56, v5
v_mfma_f32_16x16x32_bf16 v[32:35], v[172:175], v[160:163], v[32:35]
v_mul_f32 v50, s56, v6
v_mul_f32 v51, s56, v7
v_mfma_f32_16x16x32_bf16 v[32:35], v[180:183], v[212:215], v[32:35]
v_exp_f32 v48, v48
v_mfma_f32_16x16x32_bf16 v[32:35], v[188:191], v[216:219], v[32:35]
v_exp_f32 v49, v49
v_mfma_f32_16x16x32_bf16 v[32:35], v[64:67], v[220:223], v[32:35]
v_exp_f32 v50, v50
v_mfma_f32_16x16x32_bf16 v[32:35], v[148:151], v[120:123], v[32:35]
v_exp_f32 v51, v51
v_mfma_f32_16x16x32_bf16 v[32:35], v[156:159], v[224:227], v[32:35]
v_add_f32 v48, s57, v48
v_add_f32 v49, s57, v49
v_mfma_f32_16x16x32_bf16 v[32:35], v[88:91], v[228:231], v[32:35]
v_add_f32 v50, s57, v50
v_add_f32 v51, s57, v51
v_mfma_f32_16x16x32_bf16 v[32:35], v[196:199], v[136:139], v[32:35]
v_rcp_f32 v48, v48
s_waitcnt lgkmcnt(0)
v_mfma_f32_16x16x32_bf16 v[32:35], v[204:207], v[168:171], v[32:35]
v_rcp_f32 v49, v49
v_mfma_f32_16x16x32_bf16 v[32:35], v[92:95], v[80:83], v[32:35]
v_rcp_f32 v50, v50
v_mfma_f32_16x16x32_bf16 v[32:35], v[76:79], v[60:63], v[32:35]
v_rcp_f32 v51, v51
v_mfma_f32_16x16x32_bf16 v[24:27], v[116:119], v[124:127], v[24:27]
ds_read_b128 v[68:71], v43 offset:2016
v_add_f32 v48, v46, v48
v_add_f32 v49, v46, v49
v_mfma_f32_16x16x32_bf16 v[24:27], v[132:135], v[128:131], v[24:27]
v_add_f32 v50, v46, v50
v_add_f32 v51, v46, v51
v_mfma_f32_16x16x32_bf16 v[24:27], v[164:167], v[140:143], v[24:27]
v_cvt_pk_bf16_f32 v56, v48, v49
v_cvt_pk_bf16_f32 v57, v50, v51
v_mfma_f32_16x16x32_bf16 v[24:27], v[72:75], v[160:163], v[24:27]
buffer_store_dwordx2 v[56:57], v47, s[32:35], s64 offen sc1
v_mul_f32 v52, s56, v32
v_mul_f32 v53, s56, v33
v_mfma_f32_16x16x32_bf16 v[24:27], v[172:175], v[212:215], v[24:27]
v_mul_f32 v54, s56, v34
v_mul_f32 v55, s56, v35
v_mfma_f32_16x16x32_bf16 v[24:27], v[180:183], v[216:219], v[24:27]
v_exp_f32 v52, v52
v_mfma_f32_16x16x32_bf16 v[24:27], v[188:191], v[220:223], v[24:27]
v_exp_f32 v53, v53
v_mfma_f32_16x16x32_bf16 v[24:27], v[64:67], v[120:123], v[24:27]
v_exp_f32 v54, v54
v_mfma_f32_16x16x32_bf16 v[24:27], v[148:151], v[224:227], v[24:27]
v_exp_f32 v55, v55
v_mfma_f32_16x16x32_bf16 v[24:27], v[156:159], v[228:231], v[24:27]
v_add_f32 v52, s57, v52
v_add_f32 v53, s57, v53
v_mfma_f32_16x16x32_bf16 v[24:27], v[88:91], v[136:139], v[24:27]
v_add_f32 v54, s57, v54
v_add_f32 v55, s57, v55
v_mfma_f32_16x16x32_bf16 v[24:27], v[196:199], v[168:171], v[24:27]
v_rcp_f32 v52, v52
v_mfma_f32_16x16x32_bf16 v[24:27], v[204:207], v[80:83], v[24:27]
v_rcp_f32 v53, v53
v_mfma_f32_16x16x32_bf16 v[24:27], v[92:95], v[60:63], v[24:27]
v_rcp_f32 v54, v54
s_waitcnt lgkmcnt(0)
v_mfma_f32_16x16x32_bf16 v[24:27], v[76:79], v[68:71], v[24:27]
v_rcp_f32 v55, v55
v_mfma_f32_16x16x32_bf16 v[16:19], v[116:119], v[128:131], v[16:19]
ds_read_b128 v[84:87], v43 offset:1440
v_add_f32 v52, v46, v52
v_add_f32 v53, v46, v53
v_mfma_f32_16x16x32_bf16 v[16:19], v[132:135], v[140:143], v[16:19]
v_add_f32 v54, v46, v54
v_add_f32 v55, v46, v55
v_mfma_f32_16x16x32_bf16 v[16:19], v[164:167], v[160:163], v[16:19]
v_cvt_pk_bf16_f32 v58, v52, v53
v_cvt_pk_bf16_f32 v59, v54, v55
v_mfma_f32_16x16x32_bf16 v[16:19], v[72:75], v[212:215], v[16:19]
buffer_store_dwordx2 v[58:59], v47, s[32:35], s71 offen sc1
v_mul_f32 v48, s56, v24
v_mul_f32 v49, s56, v25
v_mfma_f32_16x16x32_bf16 v[16:19], v[172:175], v[216:219], v[16:19]
v_mul_f32 v50, s56, v26
v_mul_f32 v51, s56, v27
v_mfma_f32_16x16x32_bf16 v[16:19], v[180:183], v[220:223], v[16:19]
v_exp_f32 v48, v48
v_mfma_f32_16x16x32_bf16 v[16:19], v[188:191], v[120:123], v[16:19]
v_exp_f32 v49, v49
v_mfma_f32_16x16x32_bf16 v[16:19], v[64:67], v[224:227], v[16:19]
v_exp_f32 v50, v50
v_mfma_f32_16x16x32_bf16 v[16:19], v[148:151], v[228:231], v[16:19]
v_exp_f32 v51, v51
v_mfma_f32_16x16x32_bf16 v[16:19], v[156:159], v[136:139], v[16:19]
v_add_f32 v48, s57, v48
v_add_f32 v49, s57, v49
v_mfma_f32_16x16x32_bf16 v[16:19], v[88:91], v[168:171], v[16:19]
v_add_f32 v50, s57, v50
v_add_f32 v51, s57, v51
v_mfma_f32_16x16x32_bf16 v[16:19], v[196:199], v[80:83], v[16:19]
v_rcp_f32 v48, v48
v_mfma_f32_16x16x32_bf16 v[16:19], v[204:207], v[60:63], v[16:19]
v_rcp_f32 v49, v49
v_mfma_f32_16x16x32_bf16 v[16:19], v[92:95], v[68:71], v[16:19]
v_rcp_f32 v50, v50
s_waitcnt lgkmcnt(0)
v_mfma_f32_16x16x32_bf16 v[16:19], v[76:79], v[84:87], v[16:19]
v_rcp_f32 v51, v51
v_mfma_f32_16x16x32_bf16 v[8:11], v[116:119], v[140:143], v[8:11]
ds_read_b128 v[96:99], v43 offset:864
v_add_f32 v48, v46, v48
v_add_f32 v49, v46, v49
v_mfma_f32_16x16x32_bf16 v[8:11], v[132:135], v[160:163], v[8:11]
v_add_f32 v50, v46, v50
v_add_f32 v51, v46, v51
v_mfma_f32_16x16x32_bf16 v[8:11], v[164:167], v[212:215], v[8:11]
v_cvt_pk_bf16_f32 v56, v48, v49
v_cvt_pk_bf16_f32 v57, v50, v51
v_mfma_f32_16x16x32_bf16 v[8:11], v[72:75], v[216:219], v[8:11]
buffer_store_dwordx2 v[56:57], v47, s[32:35], s69 offen sc1
v_mul_f32 v52, s56, v16
v_mul_f32 v53, s56, v17
v_mfma_f32_16x16x32_bf16 v[8:11], v[172:175], v[220:223], v[8:11]
v_mul_f32 v54, s56, v18
v_mul_f32 v55, s56, v19
v_mfma_f32_16x16x32_bf16 v[8:11], v[180:183], v[120:123], v[8:11]
v_exp_f32 v52, v52
v_mfma_f32_16x16x32_bf16 v[8:11], v[188:191], v[224:227], v[8:11]
v_exp_f32 v53, v53
v_mfma_f32_16x16x32_bf16 v[8:11], v[64:67], v[228:231], v[8:11]
L_ct3:
s_cbranch_scc1 L_cr3
v_exp_f32 v54, v54
v_mfma_f32_16x16x32_bf16 v[8:11], v[148:151], v[136:139], v[8:11]
v_exp_f32 v55, v55
v_add_f32 v52, s57, v52
v_mfma_f32_16x16x32_bf16 v[8:11], v[156:159], v[168:171], v[8:11]
v_add_f32 v53, s57, v53
v_add_f32 v54, s57, v54
v_add_f32 v55, s57, v55
v_mfma_f32_16x16x32_bf16 v[8:11], v[88:91], v[80:83], v[8:11]
v_rcp_f32 v52, v52
v_mfma_f32_16x16x32_bf16 v[8:11], v[196:199], v[60:63], v[8:11]
v_rcp_f32 v53, v53
v_mfma_f32_16x16x32_bf16 v[8:11], v[204:207], v[68:71], v[8:11]
v_rcp_f32 v54, v54
v_mfma_f32_16x16x32_bf16 v[8:11], v[92:95], v[84:87], v[8:11]
v_rcp_f32 v55, v55
v_add_f32 v52, v46, v52
s_waitcnt lgkmcnt(0)
v_mfma_f32_16x16x32_bf16 v[8:11], v[76:79], v[96:99], v[8:11]
v_add_f32 v53, v46, v53
v_add_f32 v54, v46, v54
v_add_f32 v55, v46, v55
v_cvt_pk_bf16_f32 v58, v52, v53
v_cvt_pk_bf16_f32 v59, v54, v55
buffer_store_dwordx2 v[58:59], v47, s[32:35], s67 offen sc1
s_nop 1
v_mul_f32 v48, s56, v8
v_mul_f32 v49, s56, v9
v_mul_f32 v50, s56, v10
v_mul_f32 v51, s56, v11
v_exp_f32 v48, v48
v_exp_f32 v49, v49
v_exp_f32 v50, v50
v_exp_f32 v51, v51
v_add_f32 v48, s57, v48
v_add_f32 v49, s57, v49
v_add_f32 v50, s57, v50
v_add_f32 v51, s57, v51
v_rcp_f32 v48, v48
v_rcp_f32 v49, v49
v_rcp_f32 v50, v50
v_rcp_f32 v51, v51
v_add_f32 v48, v46, v48
v_add_f32 v49, v46, v49
v_add_f32 v50, v46, v50
v_add_f32 v51, v46, v51
v_cvt_pk_bf16_f32 v56, v48, v49
v_cvt_pk_bf16_f32 v57, v50, v51
buffer_store_dwordx2 v[56:57], v47, s[32:35], s65 offen sc1
s_barrier
s_waitcnt vmcnt(0)
s_barrier
L_end:
s_endpgm
.section .rodata,"a"
.p2align 6
.amdhsa_kernel standalone__autoregressive_conv_wavenet__speech_kernel
  .amdhsa_next_free_vgpr 256
  .amdhsa_next_free_sgpr 102
  .amdhsa_accum_offset 256
  .amdhsa_group_segment_fixed_size 0
  .amdhsa_kernarg_size 48
  .amdhsa_user_sgpr_count 2
  .amdhsa_user_sgpr_kernarg_segment_ptr 1
  .amdhsa_system_sgpr_workgroup_id_x 1
.end_amdhsa_kernel
```
